```python
import torch

def _softmax(x, axis=-1):
    return torch.softmax(x, dim=axis)
def _gelu(x):
    return torch.nn.functional.gelu(x, approximate="tanh")
def _silu(x):
    return torch.nn.functional.silu(x)
def _sigmoid(x):
    return torch.sigmoid(x)
def _layernorm(x, axis=-1, eps=1e-5):
    m = x.mean(dim=axis, keepdim=True)
    v = x.var(dim=axis, keepdim=True, unbiased=False)
    return (x - m) / torch.sqrt(v + eps)
def _scatter_add(tgt, idx, src, axis=0):
    return tgt.clone().index_add_(axis, idx, src)
def _segment_sum(src, seg, n):
    out = torch.zeros((n,) + src.shape[1:], dtype=src.dtype)
    return out.index_add_(0, seg, src)
def _pad(x, pw):
    flat = tuple(v for pair in reversed(pw) for v in pair)
    return torch.nn.functional.pad(x, flat)

kernel_name = 'gated_mix__linear_attn_block__sliding_local_dilated__prompt'

def setup_inputs():

    _w = (lambda a: (lambda t: t.to(torch.bfloat16) if t.is_floating_point() else t)(torch.as_tensor(a)))
    def _A_setup():
        B, S, D = 1, 2048, 512
        return {
            "x": _w((lambda *s: torch.randn(*s, dtype=torch.bfloat16) * 0.05)(B, S, D)),
            "wqkv": _w((lambda *s: torch.randn(*s, dtype=torch.bfloat16) * 1.6)(D, 3 * D)),
            "wo": _w((lambda *s: torch.randn(*s, dtype=torch.bfloat16) * 0.4)(D, D)),
        }
    _A_in = _A_setup()

    def _B_setup():
        B, S, D = 1, 2048, 512
        return {
            "x": _w((lambda *s: torch.randn(*s, dtype=torch.bfloat16) * 0.05)(B, S, D)),
            "wqkv": _w((lambda *s: torch.randn(*s, dtype=torch.bfloat16) * 0.8)(D, 3 * D)),
            "wo": _w((lambda *s: torch.randn(*s, dtype=torch.bfloat16) * 0.05)(D, D)),
        }
    _B_in = _B_setup()

    return {
        "A_x": _A_in["x"],
        "A_wqkv": _A_in["wqkv"],
        "A_wo": _A_in["wo"],
        "B_x": _B_in["x"],
        "B_wqkv": _B_in["wqkv"],
        "B_wo": _B_in["wo"],
        "gate_w": _w((lambda *s: torch.randn(*s, dtype=torch.bfloat16) * 0.05)(512) * 16.0),
    }

def reference(A_x, A_wqkv, A_wo, B_x, B_wqkv, B_wo, gate_w):
    def _A_ref(x, wqkv, wo):
        B, S, D = x.shape
        H = 32; Dh = D // H
        qkv = (lambda x, *d: x.permute(*d))((x @ wqkv).reshape(B, S, 3, H, Dh), 2, 0, 3, 1, 4)
        q, k, v = qkv[0], qkv[1], qkv[2]
        phi = lambda t: torch.where(t > 0, t + 1, torch.exp(t)) + 1e-6
        pq, pk = phi(q), phi(k)
        kv = torch.einsum("bhsd,bhse->bhde", pk, v)
        z = torch.einsum("bhsd->bhd", pk)
        num = torch.einsum("bhqd,bhde->bhqe", pq, kv)
        den = torch.einsum("bhqd,bhd->bhq", pq, z)[..., None] + 1e-6
        o = num / den
        return (lambda x, *d: x.permute(*d))(o, 0, 2, 1, 3).reshape(B, S, D) @ wo

    def _B_ref(x, wqkv, wo):
        B, S, D = x.shape
        H = 32; Dh = D // H
        W, dil = 8, 2
        qkv = (lambda x, *d: x.permute(*d))((x @ wqkv).reshape(B, S, 3, H, Dh), 2, 0, 3, 1, 4)
        q, k, v = qkv[0], qkv[1], qkv[2]
        scale = Dh ** -0.5
        pos = torch.arange(S)
        off = torch.arange(W) * dil
        idx = pos[:, None] - off[None, :]
        mask = idx >= 0
        idx_c = torch.where(mask, idx, 0).reshape(-1)
        kg = k[:, :, idx_c, :].reshape(B, H, S, W, Dh)
        vg = v[:, :, idx_c, :].reshape(B, H, S, W, Dh)
        logits = torch.einsum("bhsd,bhswd->bhsw", q, kg) * scale
        logits = torch.where(mask[None, None, :, :], logits, -1e9)
        attn = _softmax(logits, axis=-1)
        o = torch.einsum("bhsw,bhswd->bhsd", attn, vg)
        return (lambda x, *d: x.permute(*d))(o, 0, 2, 1, 3).reshape(B, S, D) @ wo

    x = A_x
    g = _sigmoid((x * gate_w).sum(-1, keepdims=True))
    a = _A_ref(x, A_wqkv, A_wo)
    b = _B_ref(x, B_wqkv, B_wo)
    return g * a + (1 - g) * b
```

```asm
; @launch grid=(256,1,1) block=(512,1,1) lds=163840
.amdgcn_target "amdgcn-amd-amdhsa--gfx950"
.text
.globl gated_mix__linear_attn_block__sliding_local_dilated__prompt_kernel
.p2align 8
.type gated_mix__linear_attn_block__sliding_local_dilated__prompt_kernel,@function
gated_mix__linear_attn_block__sliding_local_dilated__prompt_kernel:
  s_cmp_ge_u32 s2, 256
  s_cbranch_scc1 END
  s_load_dwordx4 s[4:7], s[0:1], 0
  s_load_dwordx4 s[12:15], s[0:1], 32
  s_lshr_b32 s81, s2, 3
  s_lshr_b32 s83, s2, 6
  s_lshr_b32 s33, s2, 7
  s_and_b32 s84, s2, 6
  s_and_b32 s85, s83, 1
  s_add_u32 s84, s84, s85
  s_add_u32 s84, s84, 2
  s_and_b32 s34, s84, 7
  s_lshl_b32 s85, s83, 1
  s_add_u32 s85, s85, s81
  s_and_b32 s85, s85, 3
  s_lshl_b32 s35, s85, 1
  v_lshrrev_b32 v1, 6, v0
  v_and_b32 v0, 63, v0
  v_readfirstlane_b32 s36, v1
  s_nop 0
  s_cmp_lt_u32 s36, 4
  s_cbranch_scc1 COMPUTE
LOADER:
  s_sub_u32 s37, s36, 4
  v_lshrrev_b32 v1, 3, v0
  v_and_b32 v2, 7, v0
  s_lshl_b32 s80, s37, 3
  v_add_u32 v3, s80, v1
  v_and_b32 v4, 2, v1
  v_lshlrev_b32 v4, 1, v4
  v_xor_b32 v9, v4, v2
  s_and_b32 s80, s37, 1
  s_lshl_b32 s80, s80, 1
  v_xor_b32 v4, s80, v9
  v_lshlrev_b32_e64 v4, 4, v4
  v_mul_u32_u24 v5, 3072, v3
  v_add_u32 v5, v5, v4
  s_lshl_b32 s80, s34, 7
  v_add_u32_e64 v15, s80, v5
  v_add_u32 v16, 98304, v15
  s_lshl_b32 s83, s37, 10
  s_waitcnt lgkmcnt(0)
  s_load_dword s95, s[4:5], 0
  s_cmp_eq_u32 s33, 0
  s_cselect_b32 s20, s6, s12
  s_cselect_b32 s21, s7, s13
  s_mov_b32 s22, 0x180000
  s_mov_b32 s23, 0x20000
  s_add_u32 s85, s35, 0
  s_and_b32 s85, s85, 7
  s_lshl_b32 s86, s85, 7
  s_mul_i32 s87, s85, 196608
  s_add_u32 m0, s83, 18432
  s_nop 0
  buffer_load_dwordx4 v15, s[20:23], s87 offen lds
  s_add_u32 m0, s83, 22528
  s_nop 0
  buffer_load_dwordx4 v16, s[20:23], s87 offen lds
  s_add_u32 m0, s83, 25600
  s_nop 0
  buffer_load_dwordx4 v15, s[20:23], s87 offen offset:1024 lds
  s_add_u32 m0, s83, 29696
  s_nop 0
  buffer_load_dwordx4 v16, s[20:23], s87 offen offset:1024 lds
  s_add_u32 m0, s83, 32768
  s_nop 0
  buffer_load_dwordx4 v15, s[20:23], s87 offen offset:2048 lds
  s_add_u32 m0, s83, 36864
  s_nop 0
  buffer_load_dwordx4 v16, s[20:23], s87 offen offset:2048 lds
  s_load_dwordx2 s[8:9], s[0:1], 16
  s_load_dwordx2 s[10:11], s[0:1], 48
  s_load_dwordx4 s[44:47], s[0:1], 56
  s_load_dwordx2 s[48:49], s[0:1], 72
  s_and_b32 s88, s2, 7
  s_lshr_b32 s89, s2, 3
  s_and_b32 s32, s88, 1
  s_lshl_b32 s32, s32, 3
  s_and_b32 s90, s89, 7
  s_add_u32 s32, s32, s90
  s_lshl_b32 s38, s88, 2
  s_and_b32 s90, s89, 3
  s_add_u32 s38, s38, s90
  s_lshr_b32 s39, s89, 2
  s_lshl_b32 s50, s32, 4
  s_lshl_b32 s90, s33, 3
  s_add_u32 s50, s50, s90
  s_add_u32 s50, s50, s34
  s_lshl_b32 s81, s32, 7
  s_lshl_b32 s82, s32, 17
  s_lshl_b32 s84, s37, 9
  s_mov_b32 s40, s37
  v_mov_b32 v20, 0
  v_lshlrev_b32 v19, 10, v0
  v_lshlrev_b32 v9, 4, v9
  v_lshrrev_b32 v4, 4, v3
  v_and_b32 v5, 15, v3
  v_lshlrev_b32 v5, 1, v5
  v_add_u32 v5, v5, v4
  v_lshrrev_b32 v6, 1, v3
  v_and_b32 v6, 7, v6
  v_xor_b32 v6, v6, v2
  v_lshlrev_b32 v6, 4, v6
  v_add_u32 v5, s81, v5
  v_lshlrev_b32 v5, 10, v5
  v_add_u32 v10, v5, v6
  v_add_u32 v11, 32768, v10
  v_add_u32 v12, 65536, v10
  v_add_u32 v13, 98304, v10
  s_mov_b32 s16, s4
  s_mov_b32 s17, s5
  s_mov_b32 s18, 0x200000
  s_mov_b32 s19, 0x20000
  s_add_u32 s85, s35, 0
  s_and_b32 s85, s85, 7
  s_lshl_b32 s86, s85, 7
  s_mul_i32 s87, s85, 196608
  s_add_u32 m0, s83, 0
  s_nop 0
  buffer_load_dwordx4 v10, s[16:19], s86 offen lds
  s_add_u32 m0, s83, 4096
  s_nop 0
  buffer_load_dwordx4 v11, s[16:19], s86 offen lds
  s_add_u32 m0, s83, 8192
  s_nop 0
  buffer_load_dwordx4 v12, s[16:19], s86 offen lds
  s_add_u32 m0, s83, 12288
  s_nop 0
  buffer_load_dwordx4 v13, s[16:19], s86 offen lds
  s_lshl_b32 s80, s37, 2
  v_add_u32 v4, s80, v1
  v_and_b32 v5, 7, v4
  v_lshlrev_b32 v5, 1, v5
  v_lshrrev_b32 v6, 3, v4
  v_add_u32 v5, v5, v6
  s_sub_i32 s82, s81, 16
  v_add_u32 v5, s82, v5
  v_max_i32 v5, 0, v5
  v_lshlrev_b32 v5, 10, v5
  v_lshrrev_b32 v6, 1, v4
  v_and_b32 v6, 7, v6
  v_xor_b32 v6, v6, v2
  v_lshlrev_b32 v6, 4, v6
  v_add_u32 v14, v5, v6
  s_add_u32 s85, s35, 0
  s_and_b32 s85, s85, 7
  s_lshl_b32 s86, s85, 7
  s_mul_i32 s87, s85, 196608
  s_add_u32 m0, s84, 16384
  s_mov_b32 exec_hi, 0
  buffer_load_dwordx4 v14, s[16:19], s86 offen lds
  s_mov_b64 exec, -1
  s_waitcnt lgkmcnt(0)
  v_lshlrev_b32 v17, 10, v3
  v_add_u32 v17, v17, v9
  s_lshl_b32 s80, s39, 7
  v_add_u32 v17, s80, v17
  s_mov_b32 s52, s8
  s_mov_b32 s53, s9
  s_mov_b32 s54, 0x80000
  s_mov_b32 s55, 0x20000
  s_mov_b32 s56, s14
  s_mov_b32 s57, s15
  s_mov_b32 s58, 0x80000
  s_mov_b32 s59, 0x20000
  s_mov_b32 s24, s48
  s_mov_b32 s25, s49
  s_mov_b32 s26, 0x480000
  s_mov_b32 s27, 0x20000
  s_mov_b32 s60, s44
  s_mov_b32 s61, s45
  s_mov_b32 s62, 0x200000
  s_mov_b32 s63, 0x20000
  s_add_u32 s85, s35, 1
  s_and_b32 s85, s85, 7
  s_lshl_b32 s86, s85, 7
  s_mul_i32 s87, s85, 196608
  s_add_u32 m0, s83, 61440
  s_nop 0
  buffer_load_dwordx4 v15, s[20:23], s87 offen lds
  s_add_u32 m0, s83, 65536
  s_nop 0
  buffer_load_dwordx4 v16, s[20:23], s87 offen lds
  s_add_u32 m0, s83, 68608
  s_nop 0
  buffer_load_dwordx4 v15, s[20:23], s87 offen offset:1024 lds
  s_add_u32 m0, s83, 72704
  s_nop 0
  buffer_load_dwordx4 v16, s[20:23], s87 offen offset:1024 lds
  s_add_u32 m0, s83, 75776
  s_nop 0
  buffer_load_dwordx4 v15, s[20:23], s87 offen offset:2048 lds
  s_add_u32 m0, s83, 79872
  s_nop 0
  buffer_load_dwordx4 v16, s[20:23], s87 offen offset:2048 lds
  s_add_u32 m0, s83, 43008
  s_nop 0
  buffer_load_dwordx4 v10, s[16:19], s86 offen lds
  s_waitcnt vmcnt(7)
  s_barrier
  s_add_u32 s85, s35, 1
  s_and_b32 s85, s85, 7
  s_lshl_b32 s86, s85, 7
  s_mul_i32 s87, s85, 196608
  s_add_u32 m0, s83, 47104
  s_nop 0
  buffer_load_dwordx4 v11, s[16:19], s86 offen lds
  s_add_u32 m0, s83, 51200
  s_nop 0
  buffer_load_dwordx4 v12, s[16:19], s86 offen lds
  s_add_u32 m0, s83, 55296
  s_nop 0
  buffer_load_dwordx4 v13, s[16:19], s86 offen lds
  s_add_u32 m0, s84, 59392
  s_mov_b32 exec_hi, 0
  buffer_load_dwordx4 v14, s[16:19], s86 offen lds
  s_mov_b64 exec, -1
  s_add_u32 s85, s35, 2
  s_and_b32 s85, s85, 7
  s_lshl_b32 s86, s85, 7
  s_mul_i32 s87, s85, 196608
  s_add_u32 m0, s83, 104448
  s_nop 0
  buffer_load_dwordx4 v15, s[20:23], s87 offen lds
  s_add_u32 m0, s83, 108544
  s_nop 0
  buffer_load_dwordx4 v16, s[20:23], s87 offen lds
  s_add_u32 m0, s83, 111616
  s_nop 0
  buffer_load_dwordx4 v15, s[20:23], s87 offen offset:1024 lds
  s_add_u32 m0, s83, 115712
  s_nop 0
  buffer_load_dwordx4 v16, s[20:23], s87 offen offset:1024 lds
  s_add_u32 m0, s83, 118784
  s_nop 0
  buffer_load_dwordx4 v15, s[20:23], s87 offen offset:2048 lds
  s_add_u32 m0, s83, 122880
  s_nop 0
  buffer_load_dwordx4 v16, s[20:23], s87 offen offset:2048 lds
  s_add_u32 m0, s83, 86016
  s_nop 0
  buffer_load_dwordx4 v10, s[16:19], s86 offen lds
  s_add_u32 m0, s83, 90112
  s_nop 0
  buffer_load_dwordx4 v11, s[16:19], s86 offen lds
  s_add_u32 m0, s83, 94208
  s_nop 0
  buffer_load_dwordx4 v12, s[16:19], s86 offen lds
  s_add_u32 m0, s83, 98304
  s_nop 0
  buffer_load_dwordx4 v13, s[16:19], s86 offen lds
  s_add_u32 m0, s84, 102400
  s_mov_b32 exec_hi, 0
  buffer_load_dwordx4 v14, s[16:19], s86 offen lds
  s_mov_b64 exec, -1
  s_waitcnt vmcnt(11)
  s_barrier
  s_add_u32 s85, s35, 3
  s_and_b32 s85, s85, 7
  s_lshl_b32 s86, s85, 7
  s_mul_i32 s87, s85, 196608
  s_add_u32 m0, s83, 18432
  s_nop 0
  buffer_load_dwordx4 v15, s[20:23], s87 offen lds
  s_add_u32 m0, s83, 22528
  s_nop 0
  buffer_load_dwordx4 v16, s[20:23], s87 offen lds
  s_add_u32 m0, s83, 25600
  s_nop 0
  buffer_load_dwordx4 v15, s[20:23], s87 offen offset:1024 lds
  s_add_u32 m0, s83, 29696
  s_nop 0
  buffer_load_dwordx4 v16, s[20:23], s87 offen offset:1024 lds
  s_add_u32 m0, s83, 32768
  s_nop 0
  buffer_load_dwordx4 v15, s[20:23], s87 offen offset:2048 lds
  s_add_u32 m0, s83, 36864
  s_nop 0
  buffer_load_dwordx4 v16, s[20:23], s87 offen offset:2048 lds
  s_add_u32 m0, s83, 0
  s_nop 0
  buffer_load_dwordx4 v10, s[16:19], s86 offen lds
  s_add_u32 m0, s83, 4096
  s_nop 0
  buffer_load_dwordx4 v11, s[16:19], s86 offen lds
  s_add_u32 m0, s83, 8192
  s_nop 0
  buffer_load_dwordx4 v12, s[16:19], s86 offen lds
  s_add_u32 m0, s83, 12288
  s_nop 0
  buffer_load_dwordx4 v13, s[16:19], s86 offen lds
  s_add_u32 m0, s84, 16384
  s_mov_b32 exec_hi, 0
  buffer_load_dwordx4 v14, s[16:19], s86 offen lds
  s_mov_b64 exec, -1
  s_lshr_b32 s85, s2, 3
  s_and_b32 s85, s85, 3
  s_lshl_b32 s85, s85, 2
  s_add_u32 s85, s85, s37
  s_mul_i32 s85, s85, 48
  s_add_u32 s85, s85, 0
  s_cmp_ge_u32 s85, 512
  s_cselect_b32 s86, s14, s8
  s_cselect_b32 s87, s15, s9
  s_and_b32 s85, s85, 511
  s_mov_b32 s28, s86
  s_mov_b32 s29, s87
  s_mov_b32 s30, 0x80000
  s_mov_b32 s31, 0x20000
  s_lshl_b32 s85, s85, 10
  s_lshl_b32 s86, s39, 7
  s_add_u32 s85, s85, s86
  s_mov_b32 exec_lo, 0xffff
  s_mov_b32 exec_hi, 0
  buffer_load_dword v22, v19, s[28:31], s85 offen
  s_mov_b64 exec, -1
  s_mov_b32 s85, 262144
  s_add_u32 m0, s83, 131072
  s_nop 0
  buffer_load_dwordx4 v17, s[56:59], s85 offen lds
  s_mov_b32 s85, 294912
  s_add_u32 m0, s83, 135168
  s_nop 0
  buffer_load_dwordx4 v17, s[56:59], s85 offen lds
  s_waitcnt vmcnt(14)
  s_barrier
  s_add_u32 s85, s35, 4
  s_and_b32 s85, s85, 7
  s_lshl_b32 s86, s85, 7
  s_mul_i32 s87, s85, 196608
  s_add_u32 m0, s83, 61440
  s_nop 0
  buffer_load_dwordx4 v15, s[20:23], s87 offen lds
  s_add_u32 m0, s83, 65536
  s_nop 0
  buffer_load_dwordx4 v16, s[20:23], s87 offen lds
  s_add_u32 m0, s83, 68608
  s_nop 0
  buffer_load_dwordx4 v15, s[20:23], s87 offen offset:1024 lds
  s_add_u32 m0, s83, 72704
  s_nop 0
  buffer_load_dwordx4 v16, s[20:23], s87 offen offset:1024 lds
  s_add_u32 m0, s83, 75776
  s_nop 0
  buffer_load_dwordx4 v15, s[20:23], s87 offen offset:2048 lds
  s_add_u32 m0, s83, 79872
  s_nop 0
  buffer_load_dwordx4 v16, s[20:23], s87 offen offset:2048 lds
  s_add_u32 m0, s83, 43008
  s_nop 0
  buffer_load_dwordx4 v10, s[16:19], s86 offen lds
  s_add_u32 m0, s83, 47104
  s_nop 0
  buffer_load_dwordx4 v11, s[16:19], s86 offen lds
  s_add_u32 m0, s83, 51200
  s_nop 0
  buffer_load_dwordx4 v12, s[16:19], s86 offen lds
  s_add_u32 m0, s83, 55296
  s_nop 0
  buffer_load_dwordx4 v13, s[16:19], s86 offen lds
  s_add_u32 m0, s84, 59392
  s_mov_b32 exec_hi, 0
  buffer_load_dwordx4 v14, s[16:19], s86 offen lds
  s_mov_b64 exec, -1
  s_lshr_b32 s85, s2, 3
  s_and_b32 s85, s85, 3
  s_lshl_b32 s85, s85, 2
  s_add_u32 s85, s85, s37
  s_mul_i32 s85, s85, 48
  s_add_u32 s85, s85, 16
  s_cmp_ge_u32 s85, 512
  s_cselect_b32 s86, s14, s8
  s_cselect_b32 s87, s15, s9
  s_and_b32 s85, s85, 511
  s_mov_b32 s28, s86
  s_mov_b32 s29, s87
  s_mov_b32 s30, 0x80000
  s_mov_b32 s31, 0x20000
  s_lshl_b32 s85, s85, 10
  s_lshl_b32 s86, s39, 7
  s_add_u32 s85, s85, s86
  s_mov_b32 exec_lo, 0xffff
  s_mov_b32 exec_hi, 0
  buffer_load_dword v23, v19, s[28:31], s85 offen
  s_mov_b64 exec, -1
  s_mov_b32 s85, 327680
  s_add_u32 m0, s83, 139264
  s_nop 0
  buffer_load_dwordx4 v17, s[56:59], s85 offen lds
  s_mov_b32 s85, 360448
  s_add_u32 m0, s83, 143360
  s_nop 0
  buffer_load_dwordx4 v17, s[56:59], s85 offen lds
  s_waitcnt vmcnt(17)
  s_barrier
  s_add_u32 s85, s35, 5
  s_and_b32 s85, s85, 7
  s_lshl_b32 s86, s85, 7
  s_mul_i32 s87, s85, 196608
  s_add_u32 m0, s83, 104448
  s_nop 0
  buffer_load_dwordx4 v15, s[20:23], s87 offen lds
  s_add_u32 m0, s83, 108544
  s_nop 0
  buffer_load_dwordx4 v16, s[20:23], s87 offen lds
  s_add_u32 m0, s83, 111616
  s_nop 0
  buffer_load_dwordx4 v15, s[20:23], s87 offen offset:1024 lds
  s_add_u32 m0, s83, 115712
  s_nop 0
  buffer_load_dwordx4 v16, s[20:23], s87 offen offset:1024 lds
  s_add_u32 m0, s83, 118784
  s_nop 0
  buffer_load_dwordx4 v15, s[20:23], s87 offen offset:2048 lds
  s_add_u32 m0, s83, 122880
  s_nop 0
  buffer_load_dwordx4 v16, s[20:23], s87 offen offset:2048 lds
  s_add_u32 m0, s83, 86016
  s_nop 0
  buffer_load_dwordx4 v10, s[16:19], s86 offen lds
  s_add_u32 m0, s83, 90112
  s_nop 0
  buffer_load_dwordx4 v11, s[16:19], s86 offen lds
  s_add_u32 m0, s83, 94208
  s_nop 0
  buffer_load_dwordx4 v12, s[16:19], s86 offen lds
  s_add_u32 m0, s83, 98304
  s_nop 0
  buffer_load_dwordx4 v13, s[16:19], s86 offen lds
  s_add_u32 m0, s84, 102400
  s_mov_b32 exec_hi, 0
  buffer_load_dwordx4 v14, s[16:19], s86 offen lds
  s_mov_b64 exec, -1
  s_lshr_b32 s85, s2, 3
  s_and_b32 s85, s85, 3
  s_lshl_b32 s85, s85, 2
  s_add_u32 s85, s85, s37
  s_mul_i32 s85, s85, 48
  s_add_u32 s85, s85, 32
  s_cmp_ge_u32 s85, 512
  s_cselect_b32 s86, s14, s8
  s_cselect_b32 s87, s15, s9
  s_and_b32 s85, s85, 511
  s_mov_b32 s28, s86
  s_mov_b32 s29, s87
  s_mov_b32 s30, 0x80000
  s_mov_b32 s31, 0x20000
  s_lshl_b32 s85, s85, 10
  s_lshl_b32 s86, s39, 7
  s_add_u32 s85, s85, s86
  s_mov_b32 exec_lo, 0xffff
  s_mov_b32 exec_hi, 0
  buffer_load_dword v24, v19, s[28:31], s85 offen
  s_mov_b64 exec, -1
  s_mov_b32 s85, 393216
  s_add_u32 m0, s83, 147456
  s_nop 0
  buffer_load_dwordx4 v17, s[56:59], s85 offen lds
  s_mov_b32 s85, 425984
  s_add_u32 m0, s83, 151552
  s_nop 0
  buffer_load_dwordx4 v17, s[56:59], s85 offen lds
  s_waitcnt vmcnt(17)
  s_barrier
  s_cmp_lg_u32 s37, 0
  s_cbranch_scc1 NOF1
  global_load_dwordx4 v[24:27], v20, s[46:47] sc1
NOF1:
  s_add_u32 s85, s35, 6
  s_and_b32 s85, s85, 7
  s_lshl_b32 s86, s85, 7
  s_mul_i32 s87, s85, 196608
  s_add_u32 m0, s83, 18432
  s_nop 0
  buffer_load_dwordx4 v15, s[20:23], s87 offen lds
  s_add_u32 m0, s83, 22528
  s_nop 0
  buffer_load_dwordx4 v16, s[20:23], s87 offen lds
  s_add_u32 m0, s83, 25600
  s_nop 0
  buffer_load_dwordx4 v15, s[20:23], s87 offen offset:1024 lds
  s_add_u32 m0, s83, 29696
  s_nop 0
  buffer_load_dwordx4 v16, s[20:23], s87 offen offset:1024 lds
  s_add_u32 m0, s83, 32768
  s_nop 0
  buffer_load_dwordx4 v15, s[20:23], s87 offen offset:2048 lds
  s_add_u32 m0, s83, 36864
  s_nop 0
  buffer_load_dwordx4 v16, s[20:23], s87 offen offset:2048 lds
  s_add_u32 m0, s83, 0
  s_nop 0
  buffer_load_dwordx4 v10, s[16:19], s86 offen lds
  s_add_u32 m0, s83, 4096
  s_nop 0
  buffer_load_dwordx4 v11, s[16:19], s86 offen lds
  s_add_u32 m0, s83, 8192
  s_nop 0
  buffer_load_dwordx4 v12, s[16:19], s86 offen lds
  s_add_u32 m0, s83, 12288
  s_nop 0
  buffer_load_dwordx4 v13, s[16:19], s86 offen lds
  s_add_u32 m0, s84, 16384
  s_mov_b32 exec_hi, 0
  buffer_load_dwordx4 v14, s[16:19], s86 offen lds
  s_mov_b64 exec, -1
  s_mov_b32 s85, 458752
  s_add_u32 m0, s83, 155648
  s_nop 0
  buffer_load_dwordx4 v17, s[56:59], s85 offen lds
  s_mov_b32 s85, 491520
  s_add_u32 m0, s83, 159744
  s_nop 0
  buffer_load_dwordx4 v17, s[56:59], s85 offen lds
  s_waitcnt vmcnt(16)
  s_barrier
  s_add_u32 s85, s35, 7
  s_and_b32 s85, s85, 7
  s_lshl_b32 s86, s85, 7
  s_mul_i32 s87, s85, 196608
  s_add_u32 m0, s83, 61440
  s_nop 0
  buffer_load_dwordx4 v15, s[20:23], s87 offen lds
  s_add_u32 m0, s83, 65536
  s_nop 0
  buffer_load_dwordx4 v16, s[20:23], s87 offen lds
  s_add_u32 m0, s83, 68608
  s_nop 0
  buffer_load_dwordx4 v15, s[20:23], s87 offen offset:1024 lds
  s_add_u32 m0, s83, 72704
  s_nop 0
  buffer_load_dwordx4 v16, s[20:23], s87 offen offset:1024 lds
  s_add_u32 m0, s83, 75776
  s_nop 0
  buffer_load_dwordx4 v15, s[20:23], s87 offen offset:2048 lds
  s_add_u32 m0, s83, 79872
  s_nop 0
  buffer_load_dwordx4 v16, s[20:23], s87 offen offset:2048 lds
  s_add_u32 m0, s83, 43008
  s_nop 0
  buffer_load_dwordx4 v10, s[16:19], s86 offen lds
  s_add_u32 m0, s83, 47104
  s_nop 0
  buffer_load_dwordx4 v11, s[16:19], s86 offen lds
  s_add_u32 m0, s83, 51200
  s_nop 0
  buffer_load_dwordx4 v12, s[16:19], s86 offen lds
  s_add_u32 m0, s83, 55296
  s_nop 0
  buffer_load_dwordx4 v13, s[16:19], s86 offen lds
  s_add_u32 m0, s84, 59392
  s_mov_b32 exec_hi, 0
  buffer_load_dwordx4 v14, s[16:19], s86 offen lds
  s_mov_b64 exec, -1
  s_waitcnt vmcnt(13)
  s_cmp_lg_u32 s37, 0
  s_cbranch_scc1 NOF2
  s_mov_b32 s88, 0
FCHK:
  v_readfirstlane_b32 s51, v26
  v_readfirstlane_b32 s89, v24
  v_readfirstlane_b32 s90, v25
  s_cmp_ge_u32 s34, 4
  s_cselect_b32 s89, s90, s89
  s_and_b32 s90, s34, 3
  s_lshl_b32 s90, s90, 3
  s_lshr_b32 s89, s89, s90
  s_and_b32 s89, s89, 0xff
  s_or_b32 s89, s89, s33
  s_cmp_lg_u32 s89, 0
  s_cselect_b32 s89, s51, 0
  s_cmp_lg_u32 s89, 0
  s_cbranch_scc1 NOF2
  s_add_u32 s88, s88, 1
  s_cmp_ge_u32 s88, 0x40000
  s_cbranch_scc1 NOF2
  s_sleep 4
  global_load_dwordx4 v[24:27], v20, s[46:47] sc1
  s_waitcnt vmcnt(0)
  s_branch FCHK
NOF2:
  s_barrier
  s_mov_b32 s85, 0
  s_add_u32 m0, s83, 98304
  s_nop 0
  buffer_load_dwordx4 v17, s[56:59], s85 offen lds
  s_mov_b32 s85, 32768
  s_add_u32 m0, s83, 102400
  s_nop 0
  buffer_load_dwordx4 v17, s[56:59], s85 offen lds
  s_mov_b32 s85, 65536
  s_add_u32 m0, s83, 106496
  s_nop 0
  buffer_load_dwordx4 v17, s[56:59], s85 offen lds
  s_mov_b32 s85, 98304
  s_add_u32 m0, s83, 110592
  s_nop 0
  buffer_load_dwordx4 v17, s[56:59], s85 offen lds
  s_mov_b32 s85, 131072
  s_add_u32 m0, s83, 114688
  s_nop 0
  buffer_load_dwordx4 v17, s[56:59], s85 offen lds
  s_mov_b32 s85, 163840
  s_add_u32 m0, s83, 118784
  s_nop 0
  buffer_load_dwordx4 v17, s[56:59], s85 offen lds
  s_mov_b32 s85, 196608
  s_add_u32 m0, s83, 122880
  s_nop 0
  buffer_load_dwordx4 v17, s[56:59], s85 offen lds
  s_mov_b32 s85, 229376
  s_add_u32 m0, s83, 126976
  s_nop 0
  buffer_load_dwordx4 v17, s[56:59], s85 offen lds
  s_mov_b32 s85, 425984
  s_add_u32 m0, s83, 86016
  s_nop 0
  buffer_load_dwordx4 v17, s[52:55], s85 offen lds
  s_mov_b32 s85, 458752
  s_add_u32 m0, s83, 90112
  s_nop 0
  buffer_load_dwordx4 v17, s[52:55], s85 offen lds
  s_mov_b32 s85, 491520
  s_add_u32 m0, s83, 94208
  s_nop 0
  buffer_load_dwordx4 v17, s[52:55], s85 offen lds
  s_waitcnt vmcnt(11)
  s_barrier
  s_mov_b32 s85, 0
  s_add_u32 m0, s83, 32768
  s_nop 0
  buffer_load_dwordx4 v17, s[52:55], s85 offen lds
  s_mov_b32 s85, 32768
  s_add_u32 m0, s83, 36864
  s_nop 0
  buffer_load_dwordx4 v17, s[52:55], s85 offen lds
  s_mov_b32 s94, s83
  v_mov_b32 v120, v17
  v_and_b32 v11, 15, v0
  v_lshrrev_b32 v12, 4, v0
  s_cmp_eq_u32 s33, 0
  s_cbranch_scc1 HELP_NOC
  v_lshlrev_b32_e64 v13, 2, v12
  v_mov_b32 v14, 0xf149f2ca
  v_mov_b32 v15, 0
  v_mov_b32 v248, 0
  v_mov_b32 v249, 0
  s_cmp_eq_u32 s32, 0
  s_cselect_b64 s[90:91], 0, -1
  v_add_u32 v16, 0, v13
  v_cmp_le_u32 s[82:83], v16, v11
  v_add_u32_e64 v17, 7, v16
  v_cmp_ge_u32 s[84:85], v17, v11
  v_add_u32_e64 v17, 9, v11
  v_cmp_ge_u32 s[86:87], v16, v17
  v_cmp_ge_u32 s[88:89], 7, v16
  s_and_b64 s[84:85], s[84:85], s[82:83]
  s_andn2_b64 s[88:89], s[88:89], s[82:83]
  v_cndmask_b32 v232, v14, v15, s[84:85]
  v_cndmask_b32 v236, v14, v15, s[86:87]
  s_and_b64 s[86:87], s[86:87], s[90:91]
  s_and_b64 s[88:89], s[88:89], s[90:91]
  v_cndmask_b32 v240, v14, v15, s[88:89]
  v_cndmask_b32 v244, v14, v15, s[86:87]
  v_mov_b32 v17, 0xffff
  v_cndmask_b32 v17, v15, v17, s[82:83]
  v_or_b32 v248, v248, v17
  v_add_u32 v16, 1, v13
  v_cmp_le_u32 s[82:83], v16, v11
  v_add_u32_e64 v17, 7, v16
  v_cmp_ge_u32 s[84:85], v17, v11
  v_add_u32_e64 v17, 9, v11
  v_cmp_ge_u32 s[86:87], v16, v17
  v_cmp_ge_u32 s[88:89], 7, v16
  s_and_b64 s[84:85], s[84:85], s[82:83]
  s_andn2_b64 s[88:89], s[88:89], s[82:83]
  v_cndmask_b32 v233, v14, v15, s[84:85]
  v_cndmask_b32 v237, v14, v15, s[86:87]
  s_and_b64 s[86:87], s[86:87], s[90:91]
  s_and_b64 s[88:89], s[88:89], s[90:91]
  v_cndmask_b32 v241, v14, v15, s[88:89]
  v_cndmask_b32 v245, v14, v15, s[86:87]
  v_mov_b32 v17, 0xffff0000
  v_cndmask_b32 v17, v15, v17, s[82:83]
  v_or_b32 v248, v248, v17
  v_add_u32 v16, 2, v13
  v_cmp_le_u32 s[82:83], v16, v11
  v_add_u32_e64 v17, 7, v16
  v_cmp_ge_u32 s[84:85], v17, v11
  v_add_u32_e64 v17, 9, v11
  v_cmp_ge_u32 s[86:87], v16, v17
  v_cmp_ge_u32 s[88:89], 7, v16
  s_and_b64 s[84:85], s[84:85], s[82:83]
  s_andn2_b64 s[88:89], s[88:89], s[82:83]
  v_cndmask_b32 v234, v14, v15, s[84:85]
  v_cndmask_b32 v238, v14, v15, s[86:87]
  s_and_b64 s[86:87], s[86:87], s[90:91]
  s_and_b64 s[88:89], s[88:89], s[90:91]
  v_cndmask_b32 v242, v14, v15, s[88:89]
  v_cndmask_b32 v246, v14, v15, s[86:87]
  v_mov_b32 v17, 0xffff
  v_cndmask_b32 v17, v15, v17, s[82:83]
  v_or_b32 v249, v249, v17
  v_add_u32 v16, 3, v13
  v_cmp_le_u32 s[82:83], v16, v11
  v_add_u32_e64 v17, 7, v16
  v_cmp_ge_u32 s[84:85], v17, v11
  v_add_u32_e64 v17, 9, v11
  v_cmp_ge_u32 s[86:87], v16, v17
  v_cmp_ge_u32 s[88:89], 7, v16
  s_and_b64 s[84:85], s[84:85], s[82:83]
  s_andn2_b64 s[88:89], s[88:89], s[82:83]
  v_cndmask_b32 v235, v14, v15, s[84:85]
  v_cndmask_b32 v239, v14, v15, s[86:87]
  s_and_b64 s[86:87], s[86:87], s[90:91]
  s_and_b64 s[88:89], s[88:89], s[90:91]
  v_cndmask_b32 v243, v14, v15, s[88:89]
  v_cndmask_b32 v247, v14, v15, s[86:87]
  v_mov_b32 v17, 0xffff0000
  v_cndmask_b32 v17, v15, v17, s[82:83]
  v_or_b32 v249, v249, v17
  v_not_b32 v250, v248
  v_not_b32_e64 v251, v249
  v_mov_b32 v252, 0x3f803f80
  v_mov_b32 v253, 0x3f803f80
  v_mov_b32 v254, 0x3f803f80
  v_mov_b32 v255, 0x3f803f80
HELP_NOC:
  s_lshl_b32 s82, s34, 2
  s_add_u32 s82, s82, 0
  s_and_b32 s82, s82, 31
  s_lshl_b32 s82, s82, 10
  s_add_u32 s96, s82, 0
  s_lshl_b32 s82, s34, 2
  s_add_u32 s82, s82, 8
  s_and_b32 s82, s82, 31
  s_lshl_b32 s82, s82, 10
  s_add_u32 s97, s82, 32768
  s_lshl_b32 s82, s34, 2
  s_add_u32 s82, s82, 16
  s_and_b32 s82, s82, 31
  s_lshl_b32 s82, s82, 10
  s_add_u32 s98, s82, 65536
  s_lshl_b32 s82, s34, 2
  s_add_u32 s82, s82, 24
  s_and_b32 s82, s82, 31
  s_lshl_b32 s82, s82, 10
  s_add_u32 s99, s82, 98304
  s_lshl_b32 s82, s32, 17
  s_lshl_b32 s83, s40, 10
  s_add_u32 s82, s82, s83
  s_mul_i32 s83, s33, 0x200000
  s_add_u32 s82, s82, s83
  v_lshlrev_b32 v121, 4, v0
  v_add_u32 v121, s82, v121
  s_lshl_b32 s82, s40, 13
  s_add_u32 s82, s82, 0
  v_lshlrev_b32 v122, 4, v0
  v_add_u32 v122, s82, v122
  s_barrier
  s_mov_b32 s83, s94
  v_mov_b32 v17, v120
  s_cmp_eq_u32 s33, 0
  s_cbranch_scc1 HP_A
  s_setprio 2
  s_branch HP_E
HP_A:
  s_setprio 2
HP_E:
  s_barrier
  ds_read_b128 v[24:27], v122 offset:0
  ds_read_b128 v[28:31], v122 offset:1024
  ds_read_b128 v[32:35], v122 offset:2048
  ds_read_b128 v[36:39], v122 offset:3072
  ds_read_b128 v[40:43], v122 offset:4096
  ds_read_b128 v[44:47], v122 offset:5120
  ds_read_b128 v[48:51], v122 offset:6144
  ds_read_b128 v[52:55], v122 offset:7168
  s_mov_b32 s85, 65536
  s_add_u32 m0, s83, 40960
  s_nop 0
  buffer_load_dwordx4 v17, s[52:55], s85 offen lds
  s_mov_b32 s85, 98304
  s_add_u32 m0, s83, 45056
  s_nop 0
  buffer_load_dwordx4 v17, s[52:55], s85 offen lds
  s_mov_b32 s85, 131072
  s_add_u32 m0, s83, 49152
  s_nop 0
  buffer_load_dwordx4 v17, s[52:55], s85 offen lds
  s_mov_b32 s85, 163840
  s_add_u32 m0, s83, 53248
  s_nop 0
  buffer_load_dwordx4 v17, s[52:55], s85 offen lds
  s_mov_b32 s85, 196608
  s_add_u32 m0, s83, 57344
  s_nop 0
  buffer_load_dwordx4 v17, s[52:55], s85 offen lds
  s_mov_b32 s85, 229376
  s_add_u32 m0, s83, 61440
  s_nop 0
  buffer_load_dwordx4 v17, s[52:55], s85 offen lds
  s_mov_b32 s85, 262144
  s_add_u32 m0, s83, 65536
  s_nop 0
  buffer_load_dwordx4 v17, s[52:55], s85 offen lds
  s_mov_b32 s85, 294912
  s_add_u32 m0, s83, 69632
  s_nop 0
  buffer_load_dwordx4 v17, s[52:55], s85 offen lds
  s_mov_b32 s85, 327680
  s_add_u32 m0, s83, 73728
  s_nop 0
  buffer_load_dwordx4 v17, s[52:55], s85 offen lds
  s_mov_b32 s85, 360448
  s_add_u32 m0, s83, 77824
  s_nop 0
  buffer_load_dwordx4 v17, s[52:55], s85 offen lds
  s_mov_b32 s85, 393216
  s_add_u32 m0, s83, 81920
  s_nop 0
  buffer_load_dwordx4 v17, s[52:55], s85 offen lds
  s_cmp_eq_u32 s33, 0
  s_cbranch_scc1 HELP_A
  s_mov_b32 s42, 0x3eb8aa3b
  s_mov_b32 s43, 0xbeb8aa3b
  s_waitcnt lgkmcnt(0)
  v_mfma_f32_16x16x16_bf16 v[128:131], v[36:37], v[24:25], v[232:235]
  v_mfma_f32_16x16x16_bf16 v[132:135], v[32:33], v[24:25], v[236:239]
  v_mfma_f32_16x16x16_bf16 v[152:155], v[38:39], v[26:27], v[232:235]
  v_mfma_f32_16x16x16_bf16 v[156:159], v[34:35], v[26:27], v[236:239]
  v_mfma_f32_16x16x16_bf16 v[176:179], v[40:41], v[28:29], v[232:235]
  v_mfma_f32_16x16x16_bf16 v[180:183], v[36:37], v[28:29], v[236:239]
  v_mfma_f32_16x16x16_bf16 v[200:203], v[42:43], v[30:31], v[232:235]
  v_mfma_f32_16x16x16_bf16 v[204:207], v[38:39], v[30:31], v[236:239]
  s_nop 1
  v_max_f32 v128, v128, v132
  v_max_f32 v129, v129, v133
  v_max_f32 v130, v130, v134
  v_max_f32 v131, v131, v135
  v_max_f32 v152, v152, v156
  v_max_f32 v153, v153, v157
  v_max_f32 v154, v154, v158
  v_max_f32 v155, v155, v159
  v_max_f32 v176, v176, v180
  v_max_f32 v177, v177, v181
  v_max_f32 v178, v178, v182
  v_max_f32 v179, v179, v183
  v_max_f32 v200, v200, v204
  v_max_f32 v201, v201, v205
  v_max_f32 v202, v202, v206
  v_max_f32_e64 v203, v203, v207
  v_max3_f32 v148, v128, v129, v130
  v_max3_f32 v172, v152, v153, v154
  v_max3_f32 v196, v176, v177, v178
  v_max3_f32 v220, v200, v201, v202
  v_max_f32 v148, v148, v131
  v_max_f32 v172, v172, v155
  v_max_f32 v196, v196, v179
  v_max_f32 v220, v220, v203
  v_permlane32_swap_b32 v148, v172
  s_nop 0
  v_permlane32_swap_b32 v196, v220
  v_max_f32 v148, v148, v172
  v_max_f32 v196, v196, v220
  s_nop 1
  v_permlane16_swap_b32 v148, v196
  v_max_f32 v148, v148, v196
  v_mul_f32 v148, s43, v148
  v_mov_b32 v196, v148
  s_nop 1
  v_permlane16_swap_b32 v148, v196
  v_mov_b32 v172, v148
  v_mov_b32 v220, v196
  s_nop 0
  v_permlane32_swap_b32 v148, v172
  v_permlane32_swap_b32 v196, v220
  s_nop 0
  v_pk_fma_f32 v[128:129], v[128:129], s[42:43], v[148:149] op_sel_hi:[1,0,0]
  v_pk_fma_f32 v[130:131], v[130:131], s[42:43], v[148:149] op_sel_hi:[1,0,0]
  v_pk_fma_f32 v[152:153], v[152:153], s[42:43], v[172:173] op_sel_hi:[1,0,0]
  v_pk_fma_f32 v[154:155], v[154:155], s[42:43], v[172:173] op_sel_hi:[1,0,0]
  v_pk_fma_f32 v[176:177], v[176:177], s[42:43], v[196:197] op_sel_hi:[1,0,0]
  v_pk_fma_f32 v[178:179], v[178:179], s[42:43], v[196:197] op_sel_hi:[1,0,0]
  v_pk_fma_f32 v[200:201], v[200:201], s[42:43], v[220:221] op_sel_hi:[1,0,0]
  v_pk_fma_f32 v[202:203], v[202:203], s[42:43], v[220:221] op_sel_hi:[1,0,0]
  v_exp_f32 v128, v128
  v_exp_f32 v129, v129
  v_exp_f32 v130, v130
  v_exp_f32 v131, v131
  v_cvt_pk_bf16_f32 v132, v128, v129
  v_cvt_pk_bf16_f32 v133, v130, v131
  v_exp_f32 v152, v152
  v_exp_f32 v153, v153
  v_exp_f32 v154, v154
  v_exp_f32 v155, v155
  v_cvt_pk_bf16_f32 v156, v152, v153
  v_cvt_pk_bf16_f32 v157, v154, v155
  v_exp_f32 v176, v176
  v_exp_f32 v177, v177
  v_exp_f32 v178, v178
  v_exp_f32 v179, v179
  v_cvt_pk_bf16_f32 v180, v176, v177
  v_cvt_pk_bf16_f32 v181, v178, v179
  v_exp_f32 v200, v200
  v_exp_f32 v201, v201
  v_exp_f32 v202, v202
  v_exp_f32 v203, v203
  v_cvt_pk_bf16_f32 v204, v200, v201
  v_cvt_pk_bf16_f32 v205, v202, v203
  v_and_b32 v136, v132, v250
  v_and_b32 v137, v133, v251
  v_and_b32 v138, v132, v248
  v_and_b32 v139, v133, v249
  v_and_b32 v160, v156, v250
  v_and_b32 v161, v157, v251
  v_and_b32 v162, v156, v248
  v_and_b32 v163, v157, v249
  v_and_b32 v184, v180, v250
  v_and_b32 v185, v181, v251
  v_and_b32 v186, v180, v248
  v_and_b32 v187, v181, v249
  v_and_b32 v208, v204, v250
  v_and_b32 v209, v205, v251
  v_and_b32 v210, v204, v248
  v_and_b32 v211, v205, v249
  v_mfma_f32_16x16x32_bf16 v[144:147], v[252:255], v[136:139], 0
  v_mfma_f32_16x16x32_bf16 v[140:143], v[44:47], v[136:139], 0
  v_mfma_f32_16x16x32_bf16 v[168:171], v[252:255], v[160:163], 0
  v_mfma_f32_16x16x32_bf16 v[164:167], v[50:53], v[160:163], 0
  v_mfma_f32_16x16x32_bf16 v[192:195], v[252:255], v[184:187], 0
  v_mfma_f32_16x16x32_bf16 v[188:191], v[46:49], v[184:187], 0
  v_mfma_f32_16x16x32_bf16 v[216:219], v[252:255], v[208:211], 0
  v_mfma_f32_16x16x32_bf16 v[212:215], v[52:55], v[208:211], 0
  s_nop 0
  v_rcp_f32 v144, v144
  s_nop 0
  v_rcp_f32 v168, v168
  s_nop 0
  v_rcp_f32 v192, v192
  s_nop 0
  v_rcp_f32 v216, v216
  v_pk_mul_f32 v[140:141], v[140:141], v[144:145] op_sel_hi:[1,0]
  v_pk_mul_f32 v[142:143], v[142:143], v[144:145] op_sel_hi:[1,0]
  v_pk_mul_f32 v[164:165], v[164:165], v[168:169] op_sel_hi:[1,0]
  v_pk_mul_f32 v[166:167], v[166:167], v[168:169] op_sel_hi:[1,0]
  v_pk_mul_f32 v[188:189], v[188:189], v[192:193] op_sel_hi:[1,0]
  v_pk_mul_f32 v[190:191], v[190:191], v[192:193] op_sel_hi:[1,0]
  v_pk_mul_f32 v[212:213], v[212:213], v[216:217] op_sel_hi:[1,0]
  v_pk_mul_f32 v[214:215], v[214:215], v[216:217] op_sel_hi:[1,0]
  v_cvt_pk_bf16_f32 v104, v140, v141
  v_cvt_pk_bf16_f32 v105, v142, v143
  v_cvt_pk_bf16_f32 v106, v164, v165
  v_cvt_pk_bf16_f32 v107, v166, v167
  v_cvt_pk_bf16_f32 v108, v188, v189
  v_cvt_pk_bf16_f32 v109, v190, v191
  v_cvt_pk_bf16_f32 v110, v212, v213
  v_cvt_pk_bf16_f32 v111, v214, v215
  v_permlane16_swap_b32 v104, v106
  v_permlane16_swap_b32 v105, v107
  v_permlane16_swap_b32 v108, v110
  v_permlane16_swap_b32 v109, v111
  buffer_store_dwordx4 v[104:107], v121, s[24:27], s98 offen sc1
  buffer_store_dwordx4 v[108:111], v121, s[24:27], s99 offen sc1
  s_branch HELP_DONE
HELP_A:
  s_mov_b32 s42, 0x3fb8aa3b
  s_mov_b32 s43, 0x358637bd
  s_waitcnt lgkmcnt(0)
  v_pk_mul_f32 v[64:65], v[24:25], s[42:43] op_sel_hi:[1,0]
  v_pk_mul_f32 v[66:67], v[26:27], s[42:43] op_sel_hi:[1,0]
  v_pk_mul_f32 v[68:69], v[28:29], s[42:43] op_sel_hi:[1,0]
  v_pk_mul_f32 v[70:71], v[30:31], s[42:43] op_sel_hi:[1,0]
  v_pk_mul_f32 v[72:73], v[32:33], s[42:43] op_sel_hi:[1,0]
  v_pk_mul_f32 v[74:75], v[34:35], s[42:43] op_sel_hi:[1,0]
  v_pk_mul_f32 v[76:77], v[36:37], s[42:43] op_sel_hi:[1,0]
  v_pk_mul_f32 v[78:79], v[38:39], s[42:43] op_sel_hi:[1,0]
  v_exp_f32 v64, v64 clamp
  v_max_f32_e64 v24, s43, v24
  v_exp_f32 v65, v65 clamp
  v_max_f32_e64 v25, s43, v25
  v_exp_f32 v66, v66 clamp
  v_max_f32_e64 v26, s43, v26
  v_exp_f32 v67, v67 clamp
  v_max_f32_e64 v27, s43, v27
  v_exp_f32 v68, v68 clamp
  v_max_f32_e64 v28, s43, v28
  v_exp_f32 v69, v69 clamp
  v_max_f32_e64 v29, s43, v29
  v_exp_f32 v70, v70 clamp
  v_max_f32_e64 v30, s43, v30
  v_exp_f32 v71, v71 clamp
  v_max_f32_e64 v31, s43, v31
  v_exp_f32 v72, v72 clamp
  v_max_f32_e64 v32, s43, v32
  v_exp_f32 v73, v73 clamp
  v_max_f32_e64 v33, s43, v33
  v_exp_f32 v74, v74 clamp
  v_max_f32_e64 v34, s43, v34
  v_exp_f32 v75, v75 clamp
  v_max_f32_e64 v35, s43, v35
  v_exp_f32 v76, v76 clamp
  v_max_f32_e64 v36, s43, v36
  v_exp_f32 v77, v77 clamp
  v_max_f32_e64 v37, s43, v37
  v_exp_f32 v78, v78 clamp
  v_max_f32_e64 v38, s43, v38
  v_exp_f32 v79, v79 clamp
  v_max_f32_e64 v39, s43, v39
  v_pk_add_f32 v[24:25], v[24:25], v[64:65]
  v_pk_add_f32 v[26:27], v[26:27], v[66:67]
  v_pk_add_f32 v[28:29], v[28:29], v[68:69]
  v_pk_add_f32 v[30:31], v[30:31], v[70:71]
  v_pk_add_f32 v[32:33], v[32:33], v[72:73]
  v_pk_add_f32 v[34:35], v[34:35], v[74:75]
  v_pk_add_f32 v[36:37], v[36:37], v[76:77]
  v_pk_add_f32 v[38:39], v[38:39], v[78:79]
  v_cvt_pk_bf16_f32 v96, v24, v25
  v_cvt_pk_bf16_f32 v97, v26, v27
  v_cvt_pk_bf16_f32 v98, v28, v29
  v_cvt_pk_bf16_f32 v99, v30, v31
  v_cvt_pk_bf16_f32 v100, v32, v33
  v_cvt_pk_bf16_f32 v101, v34, v35
  v_cvt_pk_bf16_f32 v102, v36, v37
  v_cvt_pk_bf16_f32 v103, v38, v39
  v_permlane16_swap_b32 v96, v98
  v_permlane16_swap_b32 v97, v99
  v_permlane16_swap_b32 v100, v102
  v_permlane16_swap_b32 v101, v103
  buffer_store_dwordx4 v[96:99], v121, s[24:27], s96 offen sc1
  buffer_store_dwordx4 v[100:103], v121, s[24:27], s97 offen sc1
  s_nop 1
  s_nop 0
  v_pk_mul_f32 v[64:65], v[40:41], s[42:43] op_sel_hi:[1,0]
  v_pk_mul_f32 v[66:67], v[42:43], s[42:43] op_sel_hi:[1,0]
  v_pk_mul_f32 v[68:69], v[44:45], s[42:43] op_sel_hi:[1,0]
  v_pk_mul_f32 v[70:71], v[46:47], s[42:43] op_sel_hi:[1,0]
  v_pk_mul_f32 v[72:73], v[48:49], s[42:43] op_sel_hi:[1,0]
  v_pk_mul_f32 v[74:75], v[50:51], s[42:43] op_sel_hi:[1,0]
  v_pk_mul_f32 v[76:77], v[52:53], s[42:43] op_sel_hi:[1,0]
  v_pk_mul_f32 v[78:79], v[54:55], s[42:43] op_sel_hi:[1,0]
  v_exp_f32 v64, v64 clamp
  v_max_f32_e64 v40, s43, v40
  v_exp_f32 v65, v65 clamp
  v_max_f32_e64 v41, s43, v41
  v_exp_f32 v66, v66 clamp
  v_max_f32_e64 v42, s43, v42
  v_exp_f32 v67, v67 clamp
  v_max_f32_e64 v43, s43, v43
  v_exp_f32 v68, v68 clamp
  v_max_f32_e64 v44, s43, v44
  v_exp_f32 v69, v69 clamp
  v_max_f32_e64 v45, s43, v45
  v_exp_f32 v70, v70 clamp
  v_max_f32_e64 v46, s43, v46
  v_exp_f32 v71, v71 clamp
  v_max_f32_e64 v47, s43, v47
  v_exp_f32 v72, v72 clamp
  v_max_f32_e64 v48, s43, v48
  v_exp_f32 v73, v73 clamp
  v_max_f32_e64 v49, s43, v49
  v_exp_f32 v74, v74 clamp
  v_max_f32_e64 v50, s43, v50
  v_exp_f32 v75, v75 clamp
  v_max_f32_e64 v51, s43, v51
  v_exp_f32 v76, v76 clamp
  v_max_f32_e64 v52, s43, v52
  v_exp_f32 v77, v77 clamp
  v_max_f32_e64 v53, s43, v53
  v_exp_f32 v78, v78 clamp
  v_max_f32_e64 v54, s43, v54
  v_exp_f32 v79, v79 clamp
  v_max_f32_e64 v55, s43, v55
  v_pk_add_f32 v[40:41], v[40:41], v[64:65]
  v_pk_add_f32 v[42:43], v[42:43], v[66:67]
  v_pk_add_f32 v[44:45], v[44:45], v[68:69]
  v_pk_add_f32 v[46:47], v[46:47], v[70:71]
  v_pk_add_f32 v[48:49], v[48:49], v[72:73]
  v_pk_add_f32 v[50:51], v[50:51], v[74:75]
  v_pk_add_f32 v[52:53], v[52:53], v[76:77]
  v_pk_add_f32 v[54:55], v[54:55], v[78:79]
  v_cvt_pk_bf16_f32 v96, v40, v41
  v_cvt_pk_bf16_f32 v97, v42, v43
  v_cvt_pk_bf16_f32 v98, v44, v45
  v_cvt_pk_bf16_f32 v99, v46, v47
  v_cvt_pk_bf16_f32 v100, v48, v49
  v_cvt_pk_bf16_f32 v101, v50, v51
  v_cvt_pk_bf16_f32 v102, v52, v53
  v_cvt_pk_bf16_f32 v103, v54, v55
  v_permlane16_swap_b32 v96, v98
  v_permlane16_swap_b32 v97, v99
  v_permlane16_swap_b32 v100, v102
  v_permlane16_swap_b32 v101, v103
  buffer_store_dwordx4 v[96:99], v121, s[24:27], s98 offen sc1
  buffer_store_dwordx4 v[100:103], v121, s[24:27], s99 offen sc1
  s_nop 1
HELP_DONE:
  s_branch JOIN10
COMPUTE:
  s_load_dwordx2 s[8:9], s[0:1], 16
  s_load_dwordx2 s[10:11], s[0:1], 48
  s_load_dwordx4 s[44:47], s[0:1], 56
  s_load_dwordx2 s[48:49], s[0:1], 72
  s_and_b32 s88, s2, 7
  s_lshr_b32 s89, s2, 3
  s_and_b32 s32, s88, 1
  s_lshl_b32 s32, s32, 3
  s_and_b32 s90, s89, 7
  s_add_u32 s32, s32, s90
  s_lshl_b32 s38, s88, 2
  s_and_b32 s90, s89, 3
  s_add_u32 s38, s38, s90
  s_lshr_b32 s39, s89, 2
  s_lshl_b32 s50, s32, 4
  s_lshl_b32 s90, s33, 3
  s_add_u32 s50, s50, s90
  s_add_u32 s50, s50, s34
  s_waitcnt lgkmcnt(0)
  s_mov_b32 s40, s36
  s_or_b32 s80, s2, s36
  s_cmp_lg_u32 s80, 0
  s_cbranch_scc1 NONONCE
  s_memrealtime s[80:81]
  s_waitcnt lgkmcnt(0)
  s_or_b32 s80, s80, 1
  v_mov_b32 v1, 8
  v_mov_b32 v2, s80
  s_mov_b64 exec, 1
  global_store_dword v1, v2, s[46:47] sc1
  s_mov_b64 exec, -1
NONONCE:
  s_mov_b32 s16, s4
  s_mov_b32 s17, s5
  s_mov_b32 s18, 0x200000
  s_mov_b32 s19, 0x20000
  s_mov_b32 s24, s48
  s_mov_b32 s25, s49
  s_mov_b32 s26, 0x480000
  s_mov_b32 s27, 0x20000
  s_mov_b32 s28, s10
  s_mov_b32 s29, s11
  s_mov_b32 s30, 0x400
  s_mov_b32 s31, 0x20000
  s_mov_b32 s60, s44
  s_mov_b32 s61, s45
  s_mov_b32 s62, 0x200000
  s_mov_b32 s63, 0x20000
  s_or_b32 s80, s33, s32
  s_cmp_lg_u32 s80, 0
  s_cbranch_scc1 NOZERO
  s_lshl_b32 s80, s34, 2
  s_add_u32 s80, s80, s36
  s_mul_i32 s81, s80, 1088
  s_add_u32 s81, s81, 0x400000
  v_lshlrev_b32 v1, 4, v0
  v_add_u32 v1, s81, v1
  v_mov_b32 v4, 0
  v_mov_b32 v5, 0
  v_mov_b32 v6, 0
  v_mov_b32 v7, 0
  buffer_store_dwordx4 v[4:7], v1, s[24:27], 0 offen sc1
  s_add_u32 s81, s81, 1024
  v_lshlrev_b32 v1, 2, v0
  v_add_u32 v1, s81, v1
  v_cmp_gt_u32 vcc, 16, v0
  s_nop 0
  s_and_saveexec_b64 s[82:83], vcc
  buffer_store_dword v4, v1, s[24:27], 0 offen sc1
  s_mov_b64 exec, s[82:83]
NOZERO:
  s_lshl_b32 s80, s33, 3
  s_add_u32 s80, s80, s34
  s_lshl_b32 s80, s80, 3
  s_lshl_b32 s81, s32, 7
  s_add_u32 s80, s80, s81
  s_lshl_b32 s81, s36, 1
  s_add_u32 s80, s80, s81
  v_lshrrev_b32 v1, 5, v0
  v_add_u32 v1, s80, v1
  v_and_b32 v2, 31, v0
  v_lshlrev_b32 v2, 5, v2
  v_lshlrev_b32 v3, 10, v1
  v_add_u32_e64 v3, v3, v2
  buffer_load_dwordx4 v[24:27], v3, s[16:19], 0 offen
  buffer_load_dwordx4 v[28:31], v3, s[16:19], 0 offen offset:16
  buffer_load_dwordx4 v[32:35], v2, s[28:31], 0 offen
  buffer_load_dwordx4 v[36:39], v2, s[28:31], 0 offen offset:16
  v_lshlrev_b32_e64 v22, 2, v1
  v_add_u32 v22, 0x410000, v22
  s_cmp_eq_u32 s33, 0
  s_cbranch_scc1 COMPA
  v_and_b32 v11, 15, v0
  v_lshrrev_b32 v12, 4, v0
  v_lshrrev_b32 v13, 1, v11
  v_and_b32 v13, 7, v13
  v_xor_b32 v14, v12, v13
  v_lshlrev_b32 v14, 4, v14
  v_lshlrev_b32 v15, 7, v11
  v_add_u32 v4, v14, v15
  v_xor_b32 v5, 64, v4
  v_lshrrev_b32 v13, 2, v0
  v_and_b32 v13, 3, v13
  v_and_b32 v14, 3, v0
  v_lshlrev_b32 v15, 3, v12
  v_add_u32 v15, v15, v13
  v_lshlrev_b32 v15, 7, v15
  v_and_b32 v16, 2, v13
  v_lshlrev_b32 v16, 1, v16
  v_and_b32 v17, 1, v12
  v_lshlrev_b32 v17, 1, v17
  v_or_b32 v16, v16, v17
  v_lshrrev_b32 v17, 1, v14
  s_lshl_b32 s80, s36, 1
  v_add_u32 v17, s80, v17
  v_xor_b32 v17, v17, v16
  v_lshlrev_b32 v17, 4, v17
  v_and_b32 v18, 1, v14
  v_lshlrev_b32 v18, 3, v18
  v_add_u32 v15, v15, v17
  v_add_u32_e64 v15, v15, v18
  v_add_u32 v6, 18432, v15
  v_mov_b32 v128, 0
  v_mov_b32 v129, 0
  v_mov_b32 v130, 0
  v_mov_b32 v131, 0
  v_mov_b32 v132, 0
  v_mov_b32 v133, 0
  v_mov_b32 v134, 0
  v_mov_b32 v135, 0
  v_mov_b32 v136, 0
  v_mov_b32 v137, 0
  v_mov_b32 v138, 0
  v_mov_b32 v139, 0
  v_mov_b32 v140, 0
  v_mov_b32 v141, 0
  v_mov_b32 v142, 0
  v_mov_b32 v143, 0
  v_mov_b32 v144, 0
  v_mov_b32 v145, 0
  v_mov_b32 v146, 0
  v_mov_b32 v147, 0
  v_mov_b32 v148, 0
  v_mov_b32 v149, 0
  v_mov_b32 v150, 0
  v_mov_b32 v151, 0
  v_mov_b32 v152, 0
  v_mov_b32 v153, 0
  v_mov_b32 v154, 0
  v_mov_b32 v155, 0
  v_mov_b32 v156, 0
  v_mov_b32 v157, 0
  v_mov_b32 v158, 0
  v_mov_b32 v159, 0
  v_mov_b32 v160, 0
  v_mov_b32 v161, 0
  v_mov_b32 v162, 0
  v_mov_b32 v163, 0
  v_mov_b32 v164, 0
  v_mov_b32 v165, 0
  v_mov_b32 v166, 0
  v_mov_b32 v167, 0
  v_mov_b32 v168, 0
  v_mov_b32 v169, 0
  v_mov_b32 v170, 0
  v_mov_b32 v171, 0
  v_mov_b32 v172, 0
  v_mov_b32 v173, 0
  v_mov_b32 v174, 0
  v_mov_b32 v175, 0
  v_mov_b32 v176, 0
  v_mov_b32 v177, 0
  v_mov_b32 v178, 0
  v_mov_b32 v179, 0
  v_mov_b32 v180, 0
  v_mov_b32 v181, 0
  v_mov_b32 v182, 0
  v_mov_b32 v183, 0
  v_mov_b32 v184, 0
  v_mov_b32 v185, 0
  v_mov_b32 v186, 0
  v_mov_b32 v187, 0
  v_mov_b32 v188, 0
  v_mov_b32 v189, 0
  v_mov_b32 v190, 0
  v_mov_b32 v191, 0
  v_mov_b32 v192, 0
  v_mov_b32 v193, 0
  v_mov_b32 v194, 0
  v_mov_b32 v195, 0
  v_mov_b32 v196, 0
  v_mov_b32 v197, 0
  v_mov_b32 v198, 0
  v_mov_b32 v199, 0
  v_mov_b32 v200, 0
  v_mov_b32 v201, 0
  v_mov_b32 v202, 0
  v_mov_b32 v203, 0
  v_mov_b32 v204, 0
  v_mov_b32 v205, 0
  v_mov_b32 v206, 0
  v_mov_b32 v207, 0
  v_mov_b32 v208, 0
  v_mov_b32 v209, 0
  v_mov_b32 v210, 0
  v_mov_b32 v211, 0
  v_mov_b32 v212, 0
  v_mov_b32 v213, 0
  v_mov_b32 v214, 0
  v_mov_b32 v215, 0
  v_mov_b32 v216, 0
  v_mov_b32 v217, 0
  v_mov_b32 v218, 0
  v_mov_b32 v219, 0
  v_mov_b32 v220, 0
  v_mov_b32 v221, 0
  v_mov_b32 v222, 0
  v_mov_b32 v223, 0
  v_mov_b32 v224, 0
  v_mov_b32 v225, 0
  v_mov_b32 v226, 0
  v_mov_b32 v227, 0
  v_mov_b32 v228, 0
  v_mov_b32 v229, 0
  v_mov_b32 v230, 0
  v_mov_b32 v231, 0
  v_lshlrev_b32_e64 v13, 2, v12
  v_mov_b32 v14, 0xf149f2ca
  v_mov_b32 v15, 0
  v_mov_b32 v248, 0
  v_mov_b32 v249, 0
  s_cmp_eq_u32 s32, 0
  s_cselect_b64 s[90:91], 0, -1
  v_add_u32 v16, 0, v13
  v_cmp_le_u32 s[82:83], v16, v11
  v_add_u32_e64 v17, 7, v16
  v_cmp_ge_u32 s[84:85], v17, v11
  v_add_u32_e64 v17, 9, v11
  v_cmp_ge_u32 s[86:87], v16, v17
  v_cmp_ge_u32 s[88:89], 7, v16
  s_and_b64 s[84:85], s[84:85], s[82:83]
  s_andn2_b64 s[88:89], s[88:89], s[82:83]
  v_cndmask_b32 v232, v14, v15, s[84:85]
  v_cndmask_b32 v236, v14, v15, s[86:87]
  s_and_b64 s[86:87], s[86:87], s[90:91]
  s_and_b64 s[88:89], s[88:89], s[90:91]
  v_cndmask_b32 v240, v14, v15, s[88:89]
  v_cndmask_b32 v244, v14, v15, s[86:87]
  v_mov_b32 v17, 0xffff
  v_cndmask_b32 v17, v15, v17, s[82:83]
  v_or_b32 v248, v248, v17
  v_add_u32 v16, 1, v13
  v_cmp_le_u32 s[82:83], v16, v11
  v_add_u32_e64 v17, 7, v16
  v_cmp_ge_u32 s[84:85], v17, v11
  v_add_u32_e64 v17, 9, v11
  v_cmp_ge_u32 s[86:87], v16, v17
  v_cmp_ge_u32 s[88:89], 7, v16
  s_and_b64 s[84:85], s[84:85], s[82:83]
  s_andn2_b64 s[88:89], s[88:89], s[82:83]
  v_cndmask_b32 v233, v14, v15, s[84:85]
  v_cndmask_b32 v237, v14, v15, s[86:87]
  s_and_b64 s[86:87], s[86:87], s[90:91]
  s_and_b64 s[88:89], s[88:89], s[90:91]
  v_cndmask_b32 v241, v14, v15, s[88:89]
  v_cndmask_b32 v245, v14, v15, s[86:87]
  v_mov_b32 v17, 0xffff0000
  v_cndmask_b32 v17, v15, v17, s[82:83]
  v_or_b32 v248, v248, v17
  v_add_u32 v16, 2, v13
  v_cmp_le_u32 s[82:83], v16, v11
  v_add_u32_e64 v17, 7, v16
  v_cmp_ge_u32 s[84:85], v17, v11
  v_add_u32_e64 v17, 9, v11
  v_cmp_ge_u32 s[86:87], v16, v17
  v_cmp_ge_u32 s[88:89], 7, v16
  s_and_b64 s[84:85], s[84:85], s[82:83]
  s_andn2_b64 s[88:89], s[88:89], s[82:83]
  v_cndmask_b32 v234, v14, v15, s[84:85]
  v_cndmask_b32 v238, v14, v15, s[86:87]
  s_and_b64 s[86:87], s[86:87], s[90:91]
  s_and_b64 s[88:89], s[88:89], s[90:91]
  v_cndmask_b32 v242, v14, v15, s[88:89]
  v_cndmask_b32 v246, v14, v15, s[86:87]
  v_mov_b32 v17, 0xffff
  v_cndmask_b32 v17, v15, v17, s[82:83]
  v_or_b32 v249, v249, v17
  v_add_u32 v16, 3, v13
  v_cmp_le_u32 s[82:83], v16, v11
  v_add_u32_e64 v17, 7, v16
  v_cmp_ge_u32 s[84:85], v17, v11
  v_add_u32_e64 v17, 9, v11
  v_cmp_ge_u32 s[86:87], v16, v17
  v_cmp_ge_u32 s[88:89], 7, v16
  s_and_b64 s[84:85], s[84:85], s[82:83]
  s_andn2_b64 s[88:89], s[88:89], s[82:83]
  v_cndmask_b32 v235, v14, v15, s[84:85]
  v_cndmask_b32 v239, v14, v15, s[86:87]
  s_and_b64 s[86:87], s[86:87], s[90:91]
  s_and_b64 s[88:89], s[88:89], s[90:91]
  v_cndmask_b32 v243, v14, v15, s[88:89]
  v_cndmask_b32 v247, v14, v15, s[86:87]
  v_mov_b32 v17, 0xffff0000
  v_cndmask_b32 v17, v15, v17, s[82:83]
  v_or_b32 v249, v249, v17
  v_not_b32 v250, v248
  v_not_b32_e64 v251, v249
  v_mov_b32 v252, 0x3f803f80
  v_mov_b32 v253, 0x3f803f80
  v_mov_b32 v254, 0x3f803f80
  v_mov_b32 v255, 0x3f803f80
  s_lshl_b32 s82, s34, 2
  s_add_u32 s82, s82, 0
  s_and_b32 s82, s82, 31
  s_lshl_b32 s82, s82, 10
  s_add_u32 s96, s82, 0
  s_lshl_b32 s82, s34, 2
  s_add_u32 s82, s82, 8
  s_and_b32 s82, s82, 31
  s_lshl_b32 s82, s82, 10
  s_add_u32 s97, s82, 32768
  s_lshl_b32 s82, s34, 2
  s_add_u32 s82, s82, 16
  s_and_b32 s82, s82, 31
  s_lshl_b32 s82, s82, 10
  s_add_u32 s98, s82, 65536
  s_lshl_b32 s82, s34, 2
  s_add_u32 s82, s82, 24
  s_and_b32 s82, s82, 31
  s_lshl_b32 s82, s82, 10
  s_add_u32 s99, s82, 98304
  s_lshl_b32 s82, s32, 17
  s_lshl_b32 s83, s40, 10
  s_add_u32 s82, s82, s83
  s_mul_i32 s83, s33, 0x200000
  s_add_u32 s82, s82, s83
  v_lshlrev_b32 v121, 4, v0
  v_add_u32 v121, s82, v121
  s_lshl_b32 s82, s40, 13
  s_add_u32 s82, s82, 0
  v_lshlrev_b32 v122, 4, v0
  v_add_u32 v122, s82, v122
  v_mov_b32 v20, 0
  s_waitcnt vmcnt(0)
  s_nop 0
  v_dot2_f32_bf16 v20, v24, v32, v20
  v_dot2_f32_bf16 v20, v25, v33, v20
  v_dot2_f32_bf16 v20, v26, v34, v20
  v_dot2_f32_bf16 v20, v27, v35, v20
  v_dot2_f32_bf16 v20, v28, v36, v20
  v_dot2_f32_bf16 v20, v29, v37, v20
  v_dot2_f32_bf16 v20, v30, v38, v20
  v_dot2_f32_bf16 v20, v31, v39, v20
  s_nop 2
  ds_swizzle_b32 v21, v20 offset:0x41f
  s_waitcnt lgkmcnt(0)
  v_add_f32_e64 v20, v20, v21
  ds_swizzle_b32 v21, v20 offset:0x81f
  s_waitcnt lgkmcnt(0)
  v_add_f32 v20, v20, v21
  ds_swizzle_b32 v21, v20 offset:0x101f
  s_waitcnt lgkmcnt(0)
  v_add_f32 v20, v20, v21
  ds_swizzle_b32 v21, v20 offset:0x201f
  s_waitcnt lgkmcnt(0)
  v_add_f32 v20, v20, v21
  ds_swizzle_b32 v21, v20 offset:0x401f
  s_waitcnt lgkmcnt(0)
  v_add_f32 v20, v20, v21
  v_mul_f32 v20, 0xbfb8aa3b, v20
  v_exp_f32 v20, v20
  s_nop 0
  v_add_f32 v20, 1.0, v20
  v_rcp_f32 v20, v20
  v_and_b32 v2, 31, v0
  v_cmp_eq_u32 vcc, 0, v2
  s_nop 0
  s_and_saveexec_b64 s[80:81], vcc
  buffer_store_dword v20, v22, s[24:27], 0 offen sc1
  s_mov_b64 exec, s[80:81]
  s_mov_b32 s80, 0
  s_mov_b32 s81, 0
  s_barrier
  s_getpc_b64 s[84:85]
CPF_PCB:
  s_sub_u32 s84, s84, CPF_PCB-gated_mix__linear_attn_block__sliding_local_dilated__prompt_kernel
  s_subb_u32 s85, s85, 0
  s_lshl_b32 s82, s36, 13
  v_lshlrev_b32 v125, 7, v0
  v_add_u32_e64 v125, s82, v125
  s_mov_b32 s82, CODE_END-gated_mix__linear_attn_block__sliding_local_dilated__prompt_kernel-4
  v_min_u32 v125, s82, v125
  v_and_b32 v125, -4, v125
  global_load_dword v124, v125, s[84:85]
  v_mov_b32 v8, v4
  v_mov_b32 v9, v5
  v_mov_b32_e64 v10, v6
  ds_read_b64_tr_b16 v[60:61], v10 offset:0
  ds_read_b64_tr_b16 v[62:63], v10 offset:512
  ds_read_b64_tr_b16 v[64:65], v10 offset:8192
  ds_read_b64_tr_b16 v[66:67], v10 offset:8704
  ds_read_b64_tr_b16 v[68:69], v10 offset:16384
  ds_read_b64_tr_b16 v[70:71], v10 offset:16896
  ds_read_b128 v[24:27], v8 offset:0
  ds_read_b128 v[28:31], v8 offset:2048
  ds_read_b128 v[32:35], v8 offset:4096
  ds_read_b128 v[36:39], v8 offset:6144
  ds_read_b128 v[40:43], v8 offset:8192
  ds_read_b128 v[44:47], v8 offset:10240
  ds_read_b128 v[48:51], v8 offset:12288
  ds_read_b128 v[52:55], v8 offset:14336
  ds_read_b128 v[56:59], v8 offset:16384
.p2align 6
LOOPB:
  s_waitcnt lgkmcnt(0)
  s_nop 0
  v_mfma_f32_16x16x32_bf16 v[128:131], v[60:63], v[24:27], v[128:131]
  ds_read_b64_tr_b16 v[108:109], v10 offset:4096
  v_mfma_f32_16x16x32_bf16 v[160:163], v[64:67], v[24:27], v[160:163]
  ds_read_b64_tr_b16 v[110:111], v10 offset:4608
  v_mfma_f32_16x16x32_bf16 v[196:199], v[24:27], v[68:71], v[196:199]
  ds_read_b64_tr_b16 v[112:113], v10 offset:12288
  v_mfma_f32_16x16x32_bf16 v[132:135], v[60:63], v[28:31], v[132:135]
  ds_read_b64_tr_b16 v[114:115], v10 offset:12800
  v_mfma_f32_16x16x32_bf16 v[164:167], v[64:67], v[28:31], v[164:167]
  ds_read_b64_tr_b16 v[116:117], v10 offset:20480
  v_mfma_f32_16x16x32_bf16 v[200:203], v[28:31], v[68:71], v[200:203]
  ds_read_b64_tr_b16 v[118:119], v10 offset:20992
  v_mfma_f32_16x16x32_bf16 v[136:139], v[60:63], v[32:35], v[136:139]
  ds_read_b128 v[72:75], v9 offset:0
  v_mfma_f32_16x16x32_bf16 v[168:171], v[64:67], v[32:35], v[168:171]
  ds_read_b128 v[76:79], v9 offset:2048
  v_mfma_f32_16x16x32_bf16 v[204:207], v[32:35], v[68:71], v[204:207]
  ds_read_b128 v[80:83], v9 offset:4096
  v_mfma_f32_16x16x32_bf16 v[140:143], v[60:63], v[36:39], v[140:143]
  ds_read_b128 v[84:87], v9 offset:6144
  v_mfma_f32_16x16x32_bf16 v[172:175], v[64:67], v[36:39], v[172:175]
  ds_read_b128 v[88:91], v9 offset:8192
  v_mfma_f32_16x16x32_bf16 v[208:211], v[36:39], v[68:71], v[208:211]
  ds_read_b128 v[92:95], v9 offset:10240
  v_mfma_f32_16x16x32_bf16 v[144:147], v[60:63], v[40:43], v[144:147]
  ds_read_b128 v[96:99], v9 offset:12288
  v_mfma_f32_16x16x32_bf16 v[176:179], v[64:67], v[40:43], v[176:179]
  ds_read_b128 v[100:103], v9 offset:14336
  v_mfma_f32_16x16x32_bf16 v[212:215], v[40:43], v[68:71], v[212:215]
  ds_read_b128 v[104:107], v9 offset:16384
  v_mfma_f32_16x16x32_bf16 v[148:151], v[60:63], v[44:47], v[148:151]
  s_add_u32 s80, s80, 43008
  s_cmp_eq_u32 s80, 129024
  s_cselect_b32 s80, 0, s80
  v_mfma_f32_16x16x32_bf16 v[180:183], v[64:67], v[44:47], v[180:183]
  v_add_u32 v8, s80, v4
  v_mfma_f32_16x16x32_bf16 v[216:219], v[44:47], v[68:71], v[216:219]
  v_mfma_f32_16x16x32_bf16 v[152:155], v[60:63], v[48:51], v[152:155]
  v_mfma_f32_16x16x32_bf16 v[184:187], v[64:67], v[48:51], v[184:187]
  v_mfma_f32_16x16x32_bf16 v[220:223], v[48:51], v[68:71], v[220:223]
  v_mfma_f32_16x16x32_bf16 v[156:159], v[60:63], v[52:55], v[156:159]
  v_mfma_f32_16x16x32_bf16 v[188:191], v[64:67], v[52:55], v[188:191]
  v_mfma_f32_16x16x32_bf16 v[224:227], v[52:55], v[68:71], v[224:227]
  v_mfma_f32_16x16x32_bf16 v[192:195], v[64:67], v[56:59], v[192:195]
  v_mfma_f32_16x16x32_bf16 v[228:231], v[56:59], v[68:71], v[228:231]
  s_waitcnt lgkmcnt(0)
  s_barrier
  s_cmp_eq_u32 s81, 7
  s_cbranch_scc1 LASTB
  v_add_u32_e64 v10, s80, v6
  v_mfma_f32_16x16x32_bf16 v[128:131], v[108:111], v[72:75], v[128:131]
  ds_read_b64_tr_b16 v[60:61], v10 offset:0
  v_mfma_f32_16x16x32_bf16 v[160:163], v[112:115], v[72:75], v[160:163]
  ds_read_b64_tr_b16 v[62:63], v10 offset:512
  v_mfma_f32_16x16x32_bf16 v[196:199], v[72:75], v[116:119], v[196:199]
  ds_read_b64_tr_b16 v[64:65], v10 offset:8192
  v_mfma_f32_16x16x32_bf16 v[132:135], v[108:111], v[76:79], v[132:135]
  ds_read_b64_tr_b16 v[66:67], v10 offset:8704
  v_mfma_f32_16x16x32_bf16 v[164:167], v[112:115], v[76:79], v[164:167]
  ds_read_b64_tr_b16 v[68:69], v10 offset:16384
  v_mfma_f32_16x16x32_bf16 v[200:203], v[76:79], v[116:119], v[200:203]
  ds_read_b64_tr_b16 v[70:71], v10 offset:16896
  v_mfma_f32_16x16x32_bf16 v[136:139], v[108:111], v[80:83], v[136:139]
  ds_read_b128 v[24:27], v8 offset:0
  v_mfma_f32_16x16x32_bf16 v[168:171], v[112:115], v[80:83], v[168:171]
  ds_read_b128 v[28:31], v8 offset:2048
  v_mfma_f32_16x16x32_bf16 v[204:207], v[80:83], v[116:119], v[204:207]
  ds_read_b128 v[32:35], v8 offset:4096
  v_mfma_f32_16x16x32_bf16 v[140:143], v[108:111], v[84:87], v[140:143]
  ds_read_b128 v[36:39], v8 offset:6144
  v_mfma_f32_16x16x32_bf16 v[172:175], v[112:115], v[84:87], v[172:175]
  ds_read_b128 v[40:43], v8 offset:8192
  v_mfma_f32_16x16x32_bf16 v[208:211], v[84:87], v[116:119], v[208:211]
  ds_read_b128 v[44:47], v8 offset:10240
  v_mfma_f32_16x16x32_bf16 v[144:147], v[108:111], v[88:91], v[144:147]
  ds_read_b128 v[48:51], v8 offset:12288
  v_mfma_f32_16x16x32_bf16 v[176:179], v[112:115], v[88:91], v[176:179]
  ds_read_b128 v[52:55], v8 offset:14336
  v_mfma_f32_16x16x32_bf16 v[212:215], v[88:91], v[116:119], v[212:215]
  ds_read_b128 v[56:59], v8 offset:16384
  v_mfma_f32_16x16x32_bf16 v[148:151], v[108:111], v[92:95], v[148:151]
  v_add_u32_e64 v9, s80, v5
  v_mfma_f32_16x16x32_bf16 v[180:183], v[112:115], v[92:95], v[180:183]
  s_add_u32 s81, s81, 1
  s_nop 0
  v_mfma_f32_16x16x32_bf16 v[216:219], v[92:95], v[116:119], v[216:219]
  v_mfma_f32_16x16x32_bf16 v[152:155], v[108:111], v[96:99], v[152:155]
  v_mfma_f32_16x16x32_bf16 v[184:187], v[112:115], v[96:99], v[184:187]
  v_mfma_f32_16x16x32_bf16 v[220:223], v[96:99], v[116:119], v[220:223]
  v_mfma_f32_16x16x32_bf16 v[156:159], v[108:111], v[100:103], v[156:159]
  v_mfma_f32_16x16x32_bf16 v[188:191], v[112:115], v[100:103], v[188:191]
  v_mfma_f32_16x16x32_bf16 v[224:227], v[100:103], v[116:119], v[224:227]
  v_mfma_f32_16x16x32_bf16 v[192:195], v[112:115], v[104:107], v[192:195]
  v_mfma_f32_16x16x32_bf16 v[228:231], v[104:107], v[116:119], v[228:231]
  s_branch LOOPB
LASTB:
  s_nop 0
  v_mfma_f32_16x16x32_bf16 v[168:171], v[112:115], v[80:83], v[168:171]
  v_mfma_f32_16x16x32_bf16 v[204:207], v[80:83], v[116:119], v[204:207]
  v_mfma_f32_16x16x32_bf16 v[172:175], v[112:115], v[84:87], v[172:175]
  v_mfma_f32_16x16x32_bf16 v[208:211], v[84:87], v[116:119], v[208:211]
  v_mfma_f32_16x16x32_bf16 v[176:179], v[112:115], v[88:91], v[176:179]
  v_mfma_f32_16x16x32_bf16 v[212:215], v[88:91], v[116:119], v[212:215]
  v_mfma_f32_16x16x32_bf16 v[144:147], v[108:111], v[88:91], v[144:147]
  v_mfma_f32_16x16x32_bf16 v[180:183], v[112:115], v[92:95], v[180:183]
  v_mfma_f32_16x16x32_bf16 v[216:219], v[92:95], v[116:119], v[216:219]
  v_mfma_f32_16x16x32_bf16 v[148:151], v[108:111], v[92:95], v[148:151]
  v_mfma_f32_16x16x32_bf16 v[184:187], v[112:115], v[96:99], v[184:187]
  v_mfma_f32_16x16x32_bf16 v[220:223], v[96:99], v[116:119], v[220:223]
  v_mfma_f32_16x16x32_bf16 v[152:155], v[108:111], v[96:99], v[152:155]
  v_mfma_f32_16x16x32_bf16 v[188:191], v[112:115], v[100:103], v[188:191]
  v_mfma_f32_16x16x32_bf16 v[224:227], v[100:103], v[116:119], v[224:227]
  v_mfma_f32_16x16x32_bf16 v[156:159], v[108:111], v[100:103], v[156:159]
  v_mfma_f32_16x16x32_bf16 v[128:131], v[108:111], v[72:75], v[128:131]
  v_cvt_pk_bf16_f32 v32, v168, v169
  v_cvt_pk_bf16_f32 v33, v170, v171
  v_cvt_pk_bf16_f32 v34, v172, v173
  v_cvt_pk_bf16_f32 v35, v174, v175
  v_mfma_f32_16x16x32_bf16 v[132:135], v[108:111], v[76:79], v[132:135]
  ds_write_b128 v122, v[32:35] offset:2048
  v_cvt_pk_bf16_f32 v44, v204, v205
  v_cvt_pk_bf16_f32 v45, v206, v207
  v_cvt_pk_bf16_f32 v46, v212, v213
  v_mfma_f32_16x16x32_bf16 v[136:139], v[108:111], v[80:83], v[136:139]
  v_cvt_pk_bf16_f32 v47, v214, v215
  ds_write_b128 v122, v[44:47] offset:5120
  v_cvt_pk_bf16_f32 v36, v176, v177
  v_cvt_pk_bf16_f32 v37, v178, v179
  v_mfma_f32_16x16x32_bf16 v[140:143], v[108:111], v[84:87], v[140:143]
  v_cvt_pk_bf16_f32 v38, v180, v181
  v_cvt_pk_bf16_f32 v39, v182, v183
  ds_write_b128 v122, v[36:39] offset:3072
  v_cvt_pk_bf16_f32 v24, v144, v145
  v_mfma_f32_16x16x32_bf16 v[160:163], v[112:115], v[72:75], v[160:163]
  v_cvt_pk_bf16_f32 v25, v146, v147
  v_cvt_pk_bf16_f32 v26, v148, v149
  v_cvt_pk_bf16_f32 v27, v150, v151
  ds_write_b128 v122, v[24:27] offset:0
  v_mfma_f32_16x16x32_bf16 v[164:167], v[112:115], v[76:79], v[164:167]
  v_cvt_pk_bf16_f32 v50, v208, v209
  v_cvt_pk_bf16_f32 v51, v210, v211
  v_cvt_pk_bf16_f32 v40, v184, v185
  v_cvt_pk_bf16_f32 v41, v186, v187
  v_mfma_f32_16x16x32_bf16 v[192:195], v[112:115], v[104:107], v[192:195]
  v_cvt_pk_bf16_f32 v42, v188, v189
  v_cvt_pk_bf16_f32 v43, v190, v191
  ds_write_b128 v122, v[40:43] offset:4096
  v_cvt_pk_bf16_f32 v48, v220, v221
  v_mfma_f32_16x16x32_bf16 v[196:199], v[72:75], v[116:119], v[196:199]
  v_cvt_pk_bf16_f32 v49, v222, v223
  ds_write_b128 v122, v[48:51] offset:6144
  v_cvt_pk_bf16_f32 v28, v152, v153
  v_cvt_pk_bf16_f32 v29, v154, v155
  v_mfma_f32_16x16x32_bf16 v[200:203], v[76:79], v[116:119], v[200:203]
  v_cvt_pk_bf16_f32 v30, v156, v157
  v_cvt_pk_bf16_f32 v31, v158, v159
  ds_write_b128 v122, v[28:31] offset:1024
  v_cvt_pk_bf16_f32 v52, v216, v217
  v_mfma_f32_16x16x32_bf16 v[228:231], v[104:107], v[116:119], v[228:231]
  v_cvt_pk_bf16_f32 v53, v218, v219
  v_cvt_pk_bf16_f32 v54, v224, v225
  v_cvt_pk_bf16_f32 v55, v226, v227
  ds_write_b128 v122, v[52:55] offset:7168
  s_waitcnt lgkmcnt(0)
  s_barrier
  v_cvt_pk_bf16_f32 v56, v128, v129
  v_cvt_pk_bf16_f32 v57, v130, v131
  v_cvt_pk_bf16_f32 v58, v132, v133
  v_cvt_pk_bf16_f32 v59, v134, v135
  v_cvt_pk_bf16_f32 v60, v136, v137
  v_cvt_pk_bf16_f32 v61, v138, v139
  v_cvt_pk_bf16_f32 v62, v140, v141
  v_cvt_pk_bf16_f32 v63, v142, v143
  v_cvt_pk_bf16_f32 v64, v160, v161
  v_cvt_pk_bf16_f32 v65, v162, v163
  v_cvt_pk_bf16_f32 v66, v164, v165
  v_cvt_pk_bf16_f32 v67, v166, v167
  v_cvt_pk_bf16_f32 v68, v192, v193
  v_cvt_pk_bf16_f32 v69, v194, v195
  v_cvt_pk_bf16_f32 v70, v228, v229
  v_cvt_pk_bf16_f32 v71, v230, v231
  v_cvt_pk_bf16_f32 v72, v196, v197
  v_cvt_pk_bf16_f32 v73, v198, v199
  v_cvt_pk_bf16_f32 v74, v204, v205
  v_cvt_pk_bf16_f32 v75, v206, v207
  v_cvt_pk_bf16_f32 v76, v228, v229
  v_cvt_pk_bf16_f32 v77, v230, v231
  v_cvt_pk_bf16_f32 v78, v200, v201
  v_cvt_pk_bf16_f32 v79, v202, v203
  v_cvt_pk_bf16_f32 v80, v208, v209
  v_cvt_pk_bf16_f32 v81, v210, v211
  s_mov_b32 s42, 0x3eb8aa3b
  s_mov_b32 s43, 0xbeb8aa3b
  v_mfma_f32_16x16x16_bf16 v[128:131], v[64:65], v[56:57], v[232:235]
  v_mfma_f32_16x16x16_bf16 v[132:135], v[68:69], v[56:57], v[240:243]
  v_mfma_f32_16x16x16_bf16 v[152:155], v[66:67], v[58:59], v[232:235]
  v_mfma_f32_16x16x16_bf16 v[156:159], v[68:69], v[58:59], v[244:247]
  v_mfma_f32_16x16x16_bf16 v[176:179], v[32:33], v[60:61], v[232:235]
  v_mfma_f32_16x16x16_bf16 v[180:183], v[64:65], v[60:61], v[236:239]
  v_mfma_f32_16x16x16_bf16 v[200:203], v[34:35], v[62:63], v[232:235]
  v_mfma_f32_16x16x16_bf16 v[204:207], v[66:67], v[62:63], v[236:239]
  s_nop 1
  v_max_f32 v128, v128, v132
  v_max_f32 v129, v129, v133
  v_max_f32 v130, v130, v134
  v_max_f32 v131, v131, v135
  v_max_f32 v152, v152, v156
  v_max_f32 v153, v153, v157
  v_max_f32 v154, v154, v158
  v_max_f32 v155, v155, v159
  v_max_f32 v176, v176, v180
  v_max_f32 v177, v177, v181
  v_max_f32 v178, v178, v182
  v_max_f32 v179, v179, v183
  v_max_f32 v200, v200, v204
  v_max_f32 v201, v201, v205
  v_max_f32 v202, v202, v206
  v_max_f32_e64 v203, v203, v207
  v_max3_f32 v148, v128, v129, v130
  v_max3_f32 v172, v152, v153, v154
  v_max3_f32 v196, v176, v177, v178
  v_max3_f32 v220, v200, v201, v202
  v_max_f32 v148, v148, v131
  v_max_f32 v172, v172, v155
  v_max_f32 v196, v196, v179
  v_max_f32 v220, v220, v203
  v_permlane32_swap_b32 v148, v172
  s_nop 0
  v_permlane32_swap_b32 v196, v220
  v_max_f32 v148, v148, v172
  v_max_f32 v196, v196, v220
  s_nop 1
  v_permlane16_swap_b32 v148, v196
  v_max_f32 v148, v148, v196
  v_mul_f32 v148, s43, v148
  v_mov_b32 v196, v148
  s_nop 1
  v_permlane16_swap_b32 v148, v196
  v_mov_b32 v172, v148
  v_mov_b32 v220, v196
  s_nop 0
  v_permlane32_swap_b32 v148, v172
  v_permlane32_swap_b32 v196, v220
  s_nop 0
  v_pk_fma_f32 v[128:129], v[128:129], s[42:43], v[148:149] op_sel_hi:[1,0,0]
  v_pk_fma_f32 v[130:131], v[130:131], s[42:43], v[148:149] op_sel_hi:[1,0,0]
  v_pk_fma_f32 v[152:153], v[152:153], s[42:43], v[172:173] op_sel_hi:[1,0,0]
  v_pk_fma_f32 v[154:155], v[154:155], s[42:43], v[172:173] op_sel_hi:[1,0,0]
  v_pk_fma_f32 v[176:177], v[176:177], s[42:43], v[196:197] op_sel_hi:[1,0,0]
  v_pk_fma_f32 v[178:179], v[178:179], s[42:43], v[196:197] op_sel_hi:[1,0,0]
  v_pk_fma_f32 v[200:201], v[200:201], s[42:43], v[220:221] op_sel_hi:[1,0,0]
  v_pk_fma_f32 v[202:203], v[202:203], s[42:43], v[220:221] op_sel_hi:[1,0,0]
  v_exp_f32 v128, v128
  v_exp_f32 v129, v129
  v_exp_f32 v130, v130
  v_exp_f32 v131, v131
  v_cvt_pk_bf16_f32 v132, v128, v129
  v_cvt_pk_bf16_f32 v133, v130, v131
  v_exp_f32 v152, v152
  v_exp_f32 v153, v153
  v_exp_f32 v154, v154
  v_exp_f32 v155, v155
  v_cvt_pk_bf16_f32 v156, v152, v153
  v_cvt_pk_bf16_f32 v157, v154, v155
  v_exp_f32 v176, v176
  v_exp_f32 v177, v177
  v_exp_f32 v178, v178
  v_exp_f32 v179, v179
  v_cvt_pk_bf16_f32 v180, v176, v177
  v_cvt_pk_bf16_f32 v181, v178, v179
  v_exp_f32 v200, v200
  v_exp_f32 v201, v201
  v_exp_f32 v202, v202
  v_exp_f32 v203, v203
  v_cvt_pk_bf16_f32 v204, v200, v201
  v_cvt_pk_bf16_f32 v205, v202, v203
  v_and_b32 v136, v132, v250
  v_and_b32 v137, v133, v251
  v_and_b32 v138, v132, v248
  v_and_b32 v139, v133, v249
  v_and_b32 v160, v156, v250
  v_and_b32 v161, v157, v251
  v_and_b32 v162, v156, v248
  v_and_b32 v163, v157, v249
  v_and_b32 v184, v180, v250
  v_and_b32 v185, v181, v251
  v_and_b32 v186, v180, v248
  v_and_b32 v187, v181, v249
  v_and_b32 v208, v204, v250
  v_and_b32 v209, v205, v251
  v_and_b32 v210, v204, v248
  v_and_b32 v211, v205, v249
  v_mfma_f32_16x16x32_bf16 v[144:147], v[252:255], v[136:139], 0
  v_mfma_f32_16x16x32_bf16 v[140:143], v[70:73], v[136:139], 0
  v_mfma_f32_16x16x32_bf16 v[168:171], v[252:255], v[160:163], 0
  v_mfma_f32_16x16x32_bf16 v[164:167], v[76:79], v[160:163], 0
  v_mfma_f32_16x16x32_bf16 v[192:195], v[252:255], v[184:187], 0
  v_mfma_f32_16x16x32_bf16 v[188:191], v[72:75], v[184:187], 0
  v_mfma_f32_16x16x32_bf16 v[216:219], v[252:255], v[208:211], 0
  v_mfma_f32_16x16x32_bf16 v[212:215], v[78:81], v[208:211], 0
  s_nop 0
  v_rcp_f32 v144, v144
  s_nop 0
  v_rcp_f32 v168, v168
  s_nop 0
  v_rcp_f32 v192, v192
  s_nop 0
  v_rcp_f32 v216, v216
  v_pk_mul_f32 v[140:141], v[140:141], v[144:145] op_sel_hi:[1,0]
  v_pk_mul_f32 v[142:143], v[142:143], v[144:145] op_sel_hi:[1,0]
  v_pk_mul_f32 v[164:165], v[164:165], v[168:169] op_sel_hi:[1,0]
  v_pk_mul_f32 v[166:167], v[166:167], v[168:169] op_sel_hi:[1,0]
  v_pk_mul_f32 v[188:189], v[188:189], v[192:193] op_sel_hi:[1,0]
  v_pk_mul_f32 v[190:191], v[190:191], v[192:193] op_sel_hi:[1,0]
  v_pk_mul_f32 v[212:213], v[212:213], v[216:217] op_sel_hi:[1,0]
  v_pk_mul_f32 v[214:215], v[214:215], v[216:217] op_sel_hi:[1,0]
  v_cvt_pk_bf16_f32 v104, v140, v141
  v_cvt_pk_bf16_f32 v105, v142, v143
  v_cvt_pk_bf16_f32 v106, v164, v165
  v_cvt_pk_bf16_f32 v107, v166, v167
  v_cvt_pk_bf16_f32 v108, v188, v189
  v_cvt_pk_bf16_f32 v109, v190, v191
  v_cvt_pk_bf16_f32 v110, v212, v213
  v_cvt_pk_bf16_f32 v111, v214, v215
  v_permlane16_swap_b32 v104, v106
  v_permlane16_swap_b32 v105, v107
  v_permlane16_swap_b32 v108, v110
  v_permlane16_swap_b32 v109, v111
  buffer_store_dwordx4 v[104:107], v121, s[24:27], s96 offen sc1
  buffer_store_dwordx4 v[108:111], v121, s[24:27], s97 offen sc1
  s_branch CJOIN
COMPA:
  v_and_b32 v11, 15, v0
  v_lshrrev_b32 v12, 4, v0
  v_lshrrev_b32 v13, 1, v11
  v_and_b32 v13, 7, v13
  v_xor_b32 v14, v12, v13
  v_lshlrev_b32 v14, 4, v14
  v_lshlrev_b32 v15, 7, v11
  v_add_u32 v4, v14, v15
  v_xor_b32 v5, 64, v4
  v_lshrrev_b32 v13, 2, v0
  v_and_b32 v13, 3, v13
  v_and_b32 v14, 3, v0
  v_lshlrev_b32 v15, 3, v12
  v_add_u32 v15, v15, v13
  v_lshlrev_b32 v15, 7, v15
  v_and_b32 v16, 2, v13
  v_lshlrev_b32 v16, 1, v16
  v_and_b32 v17, 1, v12
  v_lshlrev_b32 v17, 1, v17
  v_or_b32 v16, v16, v17
  v_lshrrev_b32 v17, 1, v14
  s_lshl_b32 s80, s36, 1
  v_add_u32 v17, s80, v17
  v_xor_b32 v17, v17, v16
  v_lshlrev_b32 v17, 4, v17
  v_and_b32 v18, 1, v14
  v_lshlrev_b32 v18, 3, v18
  v_add_u32 v15, v15, v17
  v_add_u32 v15, v15, v18
  v_add_u32 v6, 18432, v15
  v_mov_b32 v128, 0x358637bd
  v_mov_b32 v129, 0x358637bd
  v_mov_b32 v130, 0x358637bd
  v_mov_b32 v131, 0x358637bd
  v_mov_b32 v132, 0x358637bd
  v_mov_b32 v133, 0x358637bd
  v_mov_b32 v134, 0x358637bd
  v_mov_b32 v135, 0x358637bd
  v_mov_b32 v136, 0x358637bd
  v_mov_b32 v137, 0x358637bd
  v_mov_b32 v138, 0x358637bd
  v_mov_b32 v139, 0x358637bd
  v_mov_b32 v140, 0x358637bd
  v_mov_b32 v141, 0x358637bd
  v_mov_b32 v142, 0x358637bd
  v_mov_b32 v143, 0x358637bd
  v_mov_b32 v144, 0x358637bd
  v_mov_b32 v145, 0x358637bd
  v_mov_b32 v146, 0x358637bd
  v_mov_b32 v147, 0x358637bd
  v_mov_b32 v148, 0x358637bd
  v_mov_b32 v149, 0x358637bd
  v_mov_b32 v150, 0x358637bd
  v_mov_b32 v151, 0x358637bd
  v_mov_b32 v152, 0x358637bd
  v_mov_b32 v153, 0x358637bd
  v_mov_b32 v154, 0x358637bd
  v_mov_b32 v155, 0x358637bd
  v_mov_b32 v156, 0x358637bd
  v_mov_b32 v157, 0x358637bd
  v_mov_b32 v158, 0x358637bd
  v_mov_b32 v159, 0x358637bd
  v_mov_b32 v160, 0x358637bd
  v_mov_b32 v161, 0x358637bd
  v_mov_b32 v162, 0x358637bd
  v_mov_b32 v163, 0x358637bd
  v_mov_b32 v164, 0x358637bd
  v_mov_b32 v165, 0x358637bd
  v_mov_b32 v166, 0x358637bd
  v_mov_b32 v167, 0x358637bd
  v_mov_b32 v168, 0x358637bd
  v_mov_b32 v169, 0x358637bd
  v_mov_b32 v170, 0x358637bd
  v_mov_b32 v171, 0x358637bd
  v_mov_b32 v172, 0x358637bd
  v_mov_b32 v173, 0x358637bd
  v_mov_b32 v174, 0x358637bd
  v_mov_b32 v175, 0x358637bd
  v_mov_b32 v176, 0x358637bd
  v_mov_b32 v177, 0x358637bd
  v_mov_b32 v178, 0x358637bd
  v_mov_b32 v179, 0x358637bd
  v_mov_b32 v180, 0x358637bd
  v_mov_b32 v181, 0x358637bd
  v_mov_b32 v182, 0x358637bd
  v_mov_b32 v183, 0x358637bd
  v_mov_b32 v184, 0x358637bd
  v_mov_b32 v185, 0x358637bd
  v_mov_b32 v186, 0x358637bd
  v_mov_b32 v187, 0x358637bd
  v_mov_b32 v188, 0x358637bd
  v_mov_b32 v189, 0x358637bd
  v_mov_b32 v190, 0x358637bd
  v_mov_b32 v191, 0x358637bd
  v_mov_b32 v192, 0
  v_mov_b32 v193, 0
  v_mov_b32 v194, 0
  v_mov_b32 v195, 0
  v_mov_b32 v196, 0
  v_mov_b32 v197, 0
  v_mov_b32 v198, 0
  v_mov_b32 v199, 0
  v_mov_b32 v200, 0
  v_mov_b32 v201, 0
  v_mov_b32 v202, 0
  v_mov_b32 v203, 0
  v_mov_b32 v204, 0
  v_mov_b32 v205, 0
  v_mov_b32 v206, 0
  v_mov_b32 v207, 0
  v_mov_b32 v208, 0
  v_mov_b32 v209, 0
  v_mov_b32 v210, 0
  v_mov_b32 v211, 0
  v_mov_b32 v212, 0
  v_mov_b32 v213, 0
  v_mov_b32 v214, 0
  v_mov_b32 v215, 0
  v_mov_b32 v216, 0
  v_mov_b32 v217, 0
  v_mov_b32 v218, 0
  v_mov_b32 v219, 0
  v_mov_b32 v220, 0
  v_mov_b32 v221, 0
  v_mov_b32 v222, 0
  v_mov_b32 v223, 0
  v_mov_b32 v252, 0x3f803f80
  v_mov_b32 v253, 0x3f803f80
  v_mov_b32 v254, 0x3f803f80
  v_mov_b32 v255, 0x3f803f80
  s_lshl_b32 s83, s34, 2
  s_add_u32 s83, s83, s36
  s_mul_i32 s84, s83, 1088
  s_add_u32 s84, s84, 0x400000
  v_lshlrev_b32 v232, 8, v12
  v_lshlrev_b32 v233, 2, v11
  v_add_u32 v232, v232, v233
  v_add_u32 v232, s84, v232
  s_add_u32 s84, s84, 1024
  v_lshlrev_b32 v233, 2, v0
  v_add_u32 v233, s84, v233
  s_lshl_b32 s82, s34, 2
  s_add_u32 s82, s82, 0
  s_and_b32 s82, s82, 31
  s_lshl_b32 s82, s82, 10
  s_add_u32 s96, s82, 0
  s_lshl_b32 s82, s34, 2
  s_add_u32 s82, s82, 8
  s_and_b32 s82, s82, 31
  s_lshl_b32 s82, s82, 10
  s_add_u32 s97, s82, 32768
  s_lshl_b32 s82, s34, 2
  s_add_u32 s82, s82, 16
  s_and_b32 s82, s82, 31
  s_lshl_b32 s82, s82, 10
  s_add_u32 s98, s82, 65536
  s_lshl_b32 s82, s34, 2
  s_add_u32 s82, s82, 24
  s_and_b32 s82, s82, 31
  s_lshl_b32 s82, s82, 10
  s_add_u32 s99, s82, 98304
  s_lshl_b32 s82, s32, 17
  s_lshl_b32 s83, s40, 10
  s_add_u32 s82, s82, s83
  s_mul_i32 s83, s33, 0x200000
  s_add_u32 s82, s82, s83
  v_lshlrev_b32 v121, 4, v0
  v_add_u32 v121, s82, v121
  s_lshl_b32 s82, s40, 13
  s_add_u32 s82, s82, 0
  v_lshlrev_b32 v122, 4, v0
  v_add_u32 v122, s82, v122
  v_mov_b32 v20, 0
  s_waitcnt vmcnt(0)
  s_nop 0
  v_dot2_f32_bf16 v20, v24, v32, v20
  v_dot2_f32_bf16 v20, v25, v33, v20
  v_dot2_f32_bf16 v20, v26, v34, v20
  v_dot2_f32_bf16 v20, v27, v35, v20
  v_dot2_f32_bf16 v20, v28, v36, v20
  v_dot2_f32_bf16 v20, v29, v37, v20
  v_dot2_f32_bf16 v20, v30, v38, v20
  v_dot2_f32_bf16 v20, v31, v39, v20
  s_nop 2
  ds_swizzle_b32 v21, v20 offset:0x41f
  s_waitcnt lgkmcnt(0)
  v_add_f32_e64 v20, v20, v21
  ds_swizzle_b32 v21, v20 offset:0x81f
  s_waitcnt lgkmcnt(0)
  v_add_f32 v20, v20, v21
  ds_swizzle_b32 v21, v20 offset:0x101f
  s_waitcnt lgkmcnt(0)
  v_add_f32 v20, v20, v21
  ds_swizzle_b32 v21, v20 offset:0x201f
  s_waitcnt lgkmcnt(0)
  v_add_f32 v20, v20, v21
  ds_swizzle_b32 v21, v20 offset:0x401f
  s_waitcnt lgkmcnt(0)
  v_add_f32 v20, v20, v21
  v_mul_f32 v20, 0xbfb8aa3b, v20
  v_exp_f32 v20, v20
  s_nop 0
  v_add_f32 v20, 1.0, v20
  v_rcp_f32 v20, v20
  v_and_b32 v2, 31, v0
  v_cmp_eq_u32 vcc, 0, v2
  s_nop 0
  s_and_saveexec_b64 s[80:81], vcc
  buffer_store_dword v20, v22, s[24:27], 0 offen sc1
  s_mov_b64 exec, s[80:81]
  s_mov_b32 s80, 0
  s_mov_b32 s81, 0
  s_barrier
  s_or_b32 s82, s32, s36
  s_cmp_lg_u32 s82, 0
  s_cbranch_scc1 NOINITFLAG
  v_mov_b32 v126, s50
  v_mov_b32 v127, 1
  s_mov_b64 exec, 1
  global_store_byte v126, v127, s[46:47] sc1
  s_mov_b64 exec, -1
NOINITFLAG:
  s_getpc_b64 s[84:85]
CPF_PCA:
  s_sub_u32 s84, s84, CPF_PCA-gated_mix__linear_attn_block__sliding_local_dilated__prompt_kernel
  s_subb_u32 s85, s85, 0
  s_lshl_b32 s82, s36, 13
  v_lshlrev_b32 v125, 7, v0
  v_add_u32 v125, s82, v125
  s_mov_b32 s82, CODE_END-gated_mix__linear_attn_block__sliding_local_dilated__prompt_kernel-4
  v_min_u32 v125, s82, v125
  v_and_b32 v125, -4, v125
  global_load_dword v124, v125, s[84:85]
  v_mov_b32 v8, v4
  v_mov_b32 v9, v5
  v_mov_b32_e64 v10, v6
  ds_read_b64_tr_b16 v[60:61], v10 offset:0
  ds_read_b64_tr_b16 v[62:63], v10 offset:512
  ds_read_b64_tr_b16 v[64:65], v10 offset:8192
  ds_read_b64_tr_b16 v[66:67], v10 offset:8704
  ds_read_b64_tr_b16 v[68:69], v10 offset:16384
  ds_read_b64_tr_b16 v[70:71], v10 offset:16896
  ds_read_b128 v[24:27], v8 offset:0
  ds_read_b128 v[28:31], v8 offset:2048
  ds_read_b128 v[32:35], v8 offset:4096
  ds_read_b128 v[36:39], v8 offset:6144
  ds_read_b128 v[40:43], v8 offset:8192
  ds_read_b128 v[44:47], v8 offset:10240
  ds_read_b128 v[48:51], v8 offset:12288
  ds_read_b128 v[52:55], v8 offset:14336
.p2align 6
LOOPA:
  s_waitcnt lgkmcnt(0)
  s_nop 0
  v_mfma_f32_16x16x32_bf16 v[128:131], v[60:63], v[24:27], v[128:131]
  ds_read_b64_tr_b16 v[108:109], v10 offset:4096
  v_mfma_f32_16x16x32_bf16 v[160:163], v[24:27], v[64:67], v[160:163]
  ds_read_b64_tr_b16 v[110:111], v10 offset:4608
  v_mfma_f32_16x16x32_bf16 v[192:195], v[24:27], v[68:71], v[192:195]
  ds_read_b64_tr_b16 v[112:113], v10 offset:12288
  v_mfma_f32_16x16x32_bf16 v[132:135], v[60:63], v[28:31], v[132:135]
  ds_read_b64_tr_b16 v[114:115], v10 offset:12800
  v_mfma_f32_16x16x32_bf16 v[164:167], v[28:31], v[64:67], v[164:167]
  ds_read_b64_tr_b16 v[116:117], v10 offset:20480
  v_mfma_f32_16x16x32_bf16 v[196:199], v[28:31], v[68:71], v[196:199]
  ds_read_b64_tr_b16 v[118:119], v10 offset:20992
  v_mfma_f32_16x16x32_bf16 v[136:139], v[60:63], v[32:35], v[136:139]
  ds_read_b128 v[72:75], v9 offset:0
  v_mfma_f32_16x16x32_bf16 v[168:171], v[32:35], v[64:67], v[168:171]
  ds_read_b128 v[76:79], v9 offset:2048
  v_mfma_f32_16x16x32_bf16 v[200:203], v[32:35], v[68:71], v[200:203]
  ds_read_b128 v[80:83], v9 offset:4096
  v_mfma_f32_16x16x32_bf16 v[140:143], v[60:63], v[36:39], v[140:143]
  ds_read_b128 v[84:87], v9 offset:6144
  v_mfma_f32_16x16x32_bf16 v[172:175], v[36:39], v[64:67], v[172:175]
  ds_read_b128 v[88:91], v9 offset:8192
  v_mfma_f32_16x16x32_bf16 v[204:207], v[36:39], v[68:71], v[204:207]
  ds_read_b128 v[92:95], v9 offset:10240
  v_mfma_f32_16x16x32_bf16 v[144:147], v[60:63], v[40:43], v[144:147]
  ds_read_b128 v[96:99], v9 offset:12288
  v_mfma_f32_16x16x32_bf16 v[176:179], v[40:43], v[64:67], v[176:179]
  ds_read_b128 v[100:103], v9 offset:14336
  v_mfma_f32_16x16x32_bf16 v[208:211], v[40:43], v[68:71], v[208:211]
  s_add_u32 s80, s80, 43008
  s_cmp_eq_u32 s80, 129024
  s_cselect_b32 s80, 0, s80
  v_mfma_f32_16x16x32_bf16 v[148:151], v[60:63], v[44:47], v[148:151]
  v_add_u32 v8, s80, v4
  v_mfma_f32_16x16x32_bf16 v[180:183], v[44:47], v[64:67], v[180:183]
  v_mfma_f32_16x16x32_bf16 v[212:215], v[44:47], v[68:71], v[212:215]
  v_mfma_f32_16x16x32_bf16 v[152:155], v[60:63], v[48:51], v[152:155]
  v_mfma_f32_16x16x32_bf16 v[184:187], v[48:51], v[64:67], v[184:187]
  v_mfma_f32_16x16x32_bf16 v[216:219], v[48:51], v[68:71], v[216:219]
  v_mfma_f32_16x16x32_bf16 v[156:159], v[60:63], v[52:55], v[156:159]
  v_mfma_f32_16x16x32_bf16 v[188:191], v[52:55], v[64:67], v[188:191]
  v_mfma_f32_16x16x32_bf16 v[220:223], v[52:55], v[68:71], v[220:223]
  s_waitcnt lgkmcnt(0)
  s_barrier
  s_cmp_eq_u32 s81, 7
  s_cbranch_scc1 LASTA
  v_add_u32_e64 v10, s80, v6
  v_mfma_f32_16x16x32_bf16 v[128:131], v[108:111], v[72:75], v[128:131]
  ds_read_b64_tr_b16 v[60:61], v10 offset:0
  v_mfma_f32_16x16x32_bf16 v[160:163], v[72:75], v[112:115], v[160:163]
  ds_read_b64_tr_b16 v[62:63], v10 offset:512
  v_mfma_f32_16x16x32_bf16 v[192:195], v[72:75], v[116:119], v[192:195]
  ds_read_b64_tr_b16 v[64:65], v10 offset:8192
  v_mfma_f32_16x16x32_bf16 v[132:135], v[108:111], v[76:79], v[132:135]
  ds_read_b64_tr_b16 v[66:67], v10 offset:8704
  v_mfma_f32_16x16x32_bf16 v[164:167], v[76:79], v[112:115], v[164:167]
  ds_read_b64_tr_b16 v[68:69], v10 offset:16384
  v_mfma_f32_16x16x32_bf16 v[196:199], v[76:79], v[116:119], v[196:199]
  ds_read_b64_tr_b16 v[70:71], v10 offset:16896
  v_mfma_f32_16x16x32_bf16 v[136:139], v[108:111], v[80:83], v[136:139]
  ds_read_b128 v[24:27], v8 offset:0
  v_mfma_f32_16x16x32_bf16 v[168:171], v[80:83], v[112:115], v[168:171]
  ds_read_b128 v[28:31], v8 offset:2048
  v_mfma_f32_16x16x32_bf16 v[200:203], v[80:83], v[116:119], v[200:203]
  ds_read_b128 v[32:35], v8 offset:4096
  v_mfma_f32_16x16x32_bf16 v[140:143], v[108:111], v[84:87], v[140:143]
  ds_read_b128 v[36:39], v8 offset:6144
  v_mfma_f32_16x16x32_bf16 v[172:175], v[84:87], v[112:115], v[172:175]
  ds_read_b128 v[40:43], v8 offset:8192
  v_mfma_f32_16x16x32_bf16 v[204:207], v[84:87], v[116:119], v[204:207]
  ds_read_b128 v[44:47], v8 offset:10240
  v_mfma_f32_16x16x32_bf16 v[144:147], v[108:111], v[88:91], v[144:147]
  ds_read_b128 v[48:51], v8 offset:12288
  v_mfma_f32_16x16x32_bf16 v[176:179], v[88:91], v[112:115], v[176:179]
  ds_read_b128 v[52:55], v8 offset:14336
  v_mfma_f32_16x16x32_bf16 v[208:211], v[88:91], v[116:119], v[208:211]
  v_add_u32_e64 v9, s80, v5
  v_mfma_f32_16x16x32_bf16 v[148:151], v[108:111], v[92:95], v[148:151]
  s_add_u32 s81, s81, 1
  s_nop 0
  v_mfma_f32_16x16x32_bf16 v[180:183], v[92:95], v[112:115], v[180:183]
  v_mfma_f32_16x16x32_bf16 v[212:215], v[92:95], v[116:119], v[212:215]
  v_mfma_f32_16x16x32_bf16 v[152:155], v[108:111], v[96:99], v[152:155]
  v_mfma_f32_16x16x32_bf16 v[184:187], v[96:99], v[112:115], v[184:187]
  v_mfma_f32_16x16x32_bf16 v[216:219], v[96:99], v[116:119], v[216:219]
  v_mfma_f32_16x16x32_bf16 v[156:159], v[108:111], v[100:103], v[156:159]
  v_mfma_f32_16x16x32_bf16 v[188:191], v[100:103], v[112:115], v[188:191]
  v_mfma_f32_16x16x32_bf16 v[220:223], v[100:103], v[116:119], v[220:223]
  s_branch LOOPA
LASTA:
  s_nop 0
  v_mfma_f32_16x16x32_bf16 v[128:131], v[108:111], v[72:75], v[128:131]
  v_mfma_f32_16x16x32_bf16 v[132:135], v[108:111], v[76:79], v[132:135]
  v_mfma_f32_16x16x32_bf16 v[136:139], v[108:111], v[80:83], v[136:139]
  v_mfma_f32_16x16x32_bf16 v[140:143], v[108:111], v[84:87], v[140:143]
  v_mfma_f32_16x16x32_bf16 v[144:147], v[108:111], v[88:91], v[144:147]
  v_mfma_f32_16x16x32_bf16 v[148:151], v[108:111], v[92:95], v[148:151]
  v_mfma_f32_16x16x32_bf16 v[152:155], v[108:111], v[96:99], v[152:155]
  v_mfma_f32_16x16x32_bf16 v[156:159], v[108:111], v[100:103], v[156:159]
  v_mfma_f32_16x16x32_bf16 v[160:163], v[72:75], v[112:115], v[160:163]
  v_mfma_f32_16x16x32_bf16 v[164:167], v[76:79], v[112:115], v[164:167]
  ds_write_b128 v122, v[128:131] offset:0
  v_mfma_f32_16x16x32_bf16 v[168:171], v[80:83], v[112:115], v[168:171]
  v_mfma_f32_16x16x32_bf16 v[172:175], v[84:87], v[112:115], v[172:175]
  ds_write_b128 v122, v[132:135] offset:1024
  v_mfma_f32_16x16x32_bf16 v[176:179], v[88:91], v[112:115], v[176:179]
  v_mfma_f32_16x16x32_bf16 v[180:183], v[92:95], v[112:115], v[180:183]
  ds_write_b128 v122, v[136:139] offset:2048
  v_mfma_f32_16x16x32_bf16 v[184:187], v[96:99], v[112:115], v[184:187]
  v_mfma_f32_16x16x32_bf16 v[188:191], v[100:103], v[112:115], v[188:191]
  ds_write_b128 v122, v[140:143] offset:3072
  v_mfma_f32_16x16x32_bf16 v[192:195], v[72:75], v[116:119], v[192:195]
  v_mfma_f32_16x16x32_bf16 v[196:199], v[76:79], v[116:119], v[196:199]
  ds_write_b128 v122, v[144:147] offset:4096
  v_mfma_f32_16x16x32_bf16 v[200:203], v[80:83], v[116:119], v[200:203]
  v_mfma_f32_16x16x32_bf16 v[204:207], v[84:87], v[116:119], v[204:207]
  ds_write_b128 v122, v[148:151] offset:5120
  v_mfma_f32_16x16x32_bf16 v[208:211], v[88:91], v[116:119], v[208:211]
  v_mfma_f32_16x16x32_bf16 v[212:215], v[92:95], v[116:119], v[212:215]
  ds_write_b128 v122, v[152:155] offset:6144
  v_mfma_f32_16x16x32_bf16 v[216:219], v[96:99], v[116:119], v[216:219]
  v_mfma_f32_16x16x32_bf16 v[220:223], v[100:103], v[116:119], v[220:223]
  ds_write_b128 v122, v[156:159] offset:7168
  s_waitcnt lgkmcnt(0)
  s_barrier
  s_mov_b32 s42, 0x3fb8aa3b
  s_mov_b32 s43, 0x358637bd
  v_cvt_pk_bf16_f32 v40, v192, v193
  v_cvt_pk_bf16_f32 v41, v194, v195
  v_cvt_pk_bf16_f32 v42, v196, v197
  v_cvt_pk_bf16_f32 v43, v198, v199
  v_cvt_pk_bf16_f32 v44, v200, v201
  v_cvt_pk_bf16_f32 v45, v202, v203
  v_cvt_pk_bf16_f32 v46, v204, v205
  v_cvt_pk_bf16_f32 v47, v206, v207
  v_cvt_pk_bf16_f32 v48, v208, v209
  v_cvt_pk_bf16_f32 v49, v210, v211
  v_cvt_pk_bf16_f32 v50, v212, v213
  v_cvt_pk_bf16_f32 v51, v214, v215
  v_cvt_pk_bf16_f32 v52, v216, v217
  v_cvt_pk_bf16_f32 v53, v218, v219
  v_cvt_pk_bf16_f32 v54, v220, v221
  v_cvt_pk_bf16_f32 v55, v222, v223
  v_pk_mul_f32 v[64:65], v[160:161], s[42:43] op_sel_hi:[1,0]
  v_pk_mul_f32 v[66:67], v[162:163], s[42:43] op_sel_hi:[1,0]
  v_pk_mul_f32 v[68:69], v[164:165], s[42:43] op_sel_hi:[1,0]
  v_pk_mul_f32 v[70:71], v[166:167], s[42:43] op_sel_hi:[1,0]
  v_pk_mul_f32 v[72:73], v[168:169], s[42:43] op_sel_hi:[1,0]
  v_pk_mul_f32 v[74:75], v[170:171], s[42:43] op_sel_hi:[1,0]
  v_pk_mul_f32 v[76:77], v[172:173], s[42:43] op_sel_hi:[1,0]
  v_pk_mul_f32 v[78:79], v[174:175], s[42:43] op_sel_hi:[1,0]
  v_exp_f32 v64, v64 clamp
  v_max_f32_e64 v160, s43, v160
  v_exp_f32 v65, v65 clamp
  v_max_f32_e64 v161, s43, v161
  v_exp_f32 v66, v66 clamp
  v_max_f32_e64 v162, s43, v162
  v_exp_f32 v67, v67 clamp
  v_max_f32_e64 v163, s43, v163
  v_exp_f32 v68, v68 clamp
  v_max_f32_e64 v164, s43, v164
  v_exp_f32 v69, v69 clamp
  v_max_f32_e64 v165, s43, v165
  v_exp_f32 v70, v70 clamp
  v_max_f32_e64 v166, s43, v166
  v_exp_f32 v71, v71 clamp
  v_max_f32_e64 v167, s43, v167
  v_exp_f32 v72, v72 clamp
  v_max_f32_e64 v168, s43, v168
  v_exp_f32 v73, v73 clamp
  v_max_f32_e64 v169, s43, v169
  v_exp_f32 v74, v74 clamp
  v_max_f32_e64 v170, s43, v170
  v_exp_f32 v75, v75 clamp
  v_max_f32_e64 v171, s43, v171
  v_exp_f32 v76, v76 clamp
  v_max_f32_e64 v172, s43, v172
  v_exp_f32 v77, v77 clamp
  v_max_f32_e64 v173, s43, v173
  v_exp_f32 v78, v78 clamp
  v_max_f32_e64 v174, s43, v174
  v_exp_f32 v79, v79 clamp
  v_max_f32_e64 v175, s43, v175
  v_pk_add_f32 v[160:161], v[160:161], v[64:65]
  v_pk_add_f32 v[162:163], v[162:163], v[66:67]
  v_pk_add_f32 v[164:165], v[164:165], v[68:69]
  v_pk_add_f32 v[166:167], v[166:167], v[70:71]
  v_pk_add_f32 v[168:169], v[168:169], v[72:73]
  v_pk_add_f32 v[170:171], v[170:171], v[74:75]
  v_pk_add_f32 v[172:173], v[172:173], v[76:77]
  v_pk_add_f32 v[174:175], v[174:175], v[78:79]
  v_cvt_pk_bf16_f32 v24, v160, v161
  v_cvt_pk_bf16_f32 v25, v162, v163
  v_cvt_pk_bf16_f32 v26, v164, v165
  v_cvt_pk_bf16_f32 v27, v166, v167
  v_cvt_pk_bf16_f32 v28, v168, v169
  v_cvt_pk_bf16_f32 v29, v170, v171
  v_cvt_pk_bf16_f32 v30, v172, v173
  v_cvt_pk_bf16_f32 v31, v174, v175
  v_pk_mul_f32 v[64:65], v[176:177], s[42:43] op_sel_hi:[1,0]
  v_pk_mul_f32 v[66:67], v[178:179], s[42:43] op_sel_hi:[1,0]
  v_pk_mul_f32 v[68:69], v[180:181], s[42:43] op_sel_hi:[1,0]
  v_pk_mul_f32 v[70:71], v[182:183], s[42:43] op_sel_hi:[1,0]
  v_pk_mul_f32 v[72:73], v[184:185], s[42:43] op_sel_hi:[1,0]
  v_pk_mul_f32 v[74:75], v[186:187], s[42:43] op_sel_hi:[1,0]
  v_pk_mul_f32 v[76:77], v[188:189], s[42:43] op_sel_hi:[1,0]
  v_pk_mul_f32 v[78:79], v[190:191], s[42:43] op_sel_hi:[1,0]
  v_exp_f32 v64, v64 clamp
  v_max_f32_e64 v176, s43, v176
  v_exp_f32 v65, v65 clamp
  v_max_f32_e64 v177, s43, v177
  v_exp_f32 v66, v66 clamp
  v_max_f32_e64 v178, s43, v178
  v_exp_f32 v67, v67 clamp
  v_max_f32_e64 v179, s43, v179
  v_exp_f32 v68, v68 clamp
  v_max_f32_e64 v180, s43, v180
  v_exp_f32 v69, v69 clamp
  v_max_f32_e64 v181, s43, v181
  v_exp_f32 v70, v70 clamp
  v_max_f32_e64 v182, s43, v182
  v_exp_f32 v71, v71 clamp
  v_max_f32_e64 v183, s43, v183
  v_exp_f32 v72, v72 clamp
  v_max_f32_e64 v184, s43, v184
  v_exp_f32 v73, v73 clamp
  v_max_f32_e64 v185, s43, v185
  v_exp_f32 v74, v74 clamp
  v_max_f32_e64 v186, s43, v186
  v_exp_f32 v75, v75 clamp
  v_max_f32_e64 v187, s43, v187
  v_exp_f32 v76, v76 clamp
  v_max_f32_e64 v188, s43, v188
  v_exp_f32 v77, v77 clamp
  v_max_f32_e64 v189, s43, v189
  v_exp_f32 v78, v78 clamp
  v_max_f32_e64 v190, s43, v190
  v_exp_f32 v79, v79 clamp
  v_max_f32_e64 v191, s43, v191
  v_pk_add_f32 v[176:177], v[176:177], v[64:65]
  v_pk_add_f32 v[178:179], v[178:179], v[66:67]
  v_pk_add_f32 v[180:181], v[180:181], v[68:69]
  v_pk_add_f32 v[182:183], v[182:183], v[70:71]
  v_pk_add_f32 v[184:185], v[184:185], v[72:73]
  v_pk_add_f32 v[186:187], v[186:187], v[74:75]
  v_pk_add_f32 v[188:189], v[188:189], v[76:77]
  v_pk_add_f32 v[190:191], v[190:191], v[78:79]
  v_cvt_pk_bf16_f32 v32, v176, v177
  v_cvt_pk_bf16_f32 v33, v178, v179
  v_cvt_pk_bf16_f32 v34, v180, v181
  v_cvt_pk_bf16_f32 v35, v182, v183
  v_cvt_pk_bf16_f32 v36, v184, v185
  v_cvt_pk_bf16_f32 v37, v186, v187
  v_cvt_pk_bf16_f32 v38, v188, v189
  v_cvt_pk_bf16_f32 v39, v190, v191
  v_mfma_f32_16x16x32_bf16 v[80:83], v[40:43], v[24:27], 0
  v_mfma_f32_16x16x32_bf16 v[84:87], v[252:255], v[24:27], 0
  v_mfma_f32_16x16x32_bf16 v[80:83], v[44:47], v[28:31], v[80:83]
  v_mfma_f32_16x16x32_bf16 v[84:87], v[252:255], v[28:31], v[84:87]
  v_mfma_f32_16x16x32_bf16 v[80:83], v[48:51], v[32:35], v[80:83]
  v_mfma_f32_16x16x32_bf16 v[84:87], v[252:255], v[32:35], v[84:87]
  v_mfma_f32_16x16x32_bf16 v[80:83], v[52:55], v[36:39], v[80:83]
  v_mfma_f32_16x16x32_bf16 v[84:87], v[252:255], v[36:39], v[84:87]
  s_nop 6
  s_nop 0
  buffer_atomic_add_f32 v80, v232, s[24:27], 0 offen offset:0
  buffer_atomic_add_f32 v81, v232, s[24:27], 0 offen offset:64
  buffer_atomic_add_f32 v82, v232, s[24:27], 0 offen offset:128
  buffer_atomic_add_f32 v83, v232, s[24:27], 0 offen offset:192
  s_mov_b32 exec_lo, 0xffff
  s_mov_b32 exec_hi, 0
  buffer_atomic_add_f32 v84, v233, s[24:27], 0 offen
  s_mov_b64 exec, -1
CJOIN:
JOIN10:
  s_setprio 0
  s_and_b32 s81, s36, 1
  s_lshr_b32 s82, s36, 1
  v_and_b32 v4, 15, v0
  v_lshlrev_b32 v4, 1, v4
  v_lshrrev_b32 v5, 4, v0
  v_and_b32 v5, 1, v5
  v_add_u32 v4, v4, v5
  s_lshl_b32 s84, s38, 6
  s_lshl_b32 s85, s81, 5
  s_add_u32 s84, s84, s85
  v_add_u32 v4, s84, v4
  v_lshlrev_b32_e64 v5, 2, v4
  v_add_u32 v5, 0x410000, v5
  s_lshl_b32 s84, s38, 16
  s_lshl_b32 s85, s81, 15
  s_add_u32 s84, s84, s85
  s_lshl_b32 s85, s38, 1
  s_add_u32 s85, s85, s81
  s_add_u32 s85, s85, s82
  s_and_b32 s85, s85, 3
  s_lshl_b32 s85, s85, 13
  s_add_u32 s84, s84, s85
  v_lshlrev_b32 v3, 4, v0
  v_add_u32_e64 v8, s84, v3
  v_add_u32 v9, 4096, v8
  v_add_u32 v10, 0x200000, v8
  v_add_u32 v11, 0x200000, v9
  v_lshrrev_b32 v56, 5, v0
  v_lshrrev_b32 v57, 2, v0
  v_and_b32 v57, 3, v57
  v_and_b32 v58, 3, v0
  v_and_b32 v60, 1, v58
  v_lshlrev_b32 v60, 1, v60
  v_lshrrev_b32 v61, 4, v0
  v_and_b32 v61, 1, v61
  v_add_u32 v60, v60, v61
  v_and_b32 v61, 2, v57
  v_lshlrev_b32 v61, 1, v61
  v_xor_b32 v60, v60, v61
  v_lshlrev_b32 v60, 4, v60
  v_lshrrev_b32 v61, 1, v58
  v_lshlrev_b32 v61, 3, v61
  v_add_u32 v60, v60, v61
  s_lshl_b32 s85, s82, 14
  v_lshlrev_b32 v59, 2, v56
  v_add_u32 v59, v59, v57
  v_lshlrev_b32 v59, 7, v59
  v_add_u32_e64 v59, v59, v60
  s_add_u32 s84, s85, 32768
  v_add_u32 v12, s84, v59
  v_xor_b32 v13, 64, v12
  v_lshlrev_b32 v59, 3, v56
  v_add_u32 v59, v59, v57
  v_lshlrev_b32 v59, 7, v59
  v_add_u32 v59, v59, v60
  s_add_u32 s84, s85, 98304
  v_add_u32 v14, s84, v59
  v_xor_b32 v15, 64, v14
  v_and_b32 v22, 31, v0
  v_lshlrev_b32 v23, 5, v22
  v_lshlrev_b32 v60, 4, v56
  v_add_u32 v23, v23, v60
  v_add_u32 v60, 512, v60
  v_cmp_gt_u32 vcc, 16, v22
  s_nop 1
  v_cndmask_b32 v23, v60, v23, vcc
  s_mul_i32 s84, s82, 4352
  s_add_u32 s84, s84, 0
  v_add_u32 v23, s84, v23
  v_mov_b32 v160, 0
  v_mov_b32 v161, 0
  v_mov_b32 v162, 0
  v_mov_b32 v163, 0
  v_mov_b32 v164, 0
  v_mov_b32 v165, 0
  v_mov_b32 v166, 0
  v_mov_b32 v167, 0
  v_mov_b32 v168, 0
  v_mov_b32 v169, 0
  v_mov_b32 v170, 0
  v_mov_b32 v171, 0
  v_mov_b32 v172, 0
  v_mov_b32 v173, 0
  v_mov_b32 v174, 0
  v_mov_b32 v175, 0
  v_mov_b32 v176, 0
  v_mov_b32 v177, 0
  v_mov_b32 v178, 0
  v_mov_b32 v179, 0
  v_mov_b32 v180, 0
  v_mov_b32 v181, 0
  v_mov_b32 v182, 0
  v_mov_b32 v183, 0
  v_mov_b32 v184, 0
  v_mov_b32 v185, 0
  v_mov_b32 v186, 0
  v_mov_b32 v187, 0
  v_mov_b32 v188, 0
  v_mov_b32 v189, 0
  v_mov_b32 v190, 0
  v_mov_b32 v191, 0
  v_mov_b32 v192, 0
  v_mov_b32 v193, 0
  v_mov_b32 v194, 0
  v_mov_b32 v195, 0
  v_mov_b32 v196, 0
  v_mov_b32 v197, 0
  v_mov_b32 v198, 0
  v_mov_b32 v199, 0
  v_mov_b32 v200, 0
  v_mov_b32 v201, 0
  v_mov_b32 v202, 0
  v_mov_b32 v203, 0
  v_mov_b32 v204, 0
  v_mov_b32 v205, 0
  v_mov_b32 v206, 0
  v_mov_b32 v207, 0
  v_mov_b32 v208, 0
  v_mov_b32 v209, 0
  v_mov_b32 v210, 0
  v_mov_b32 v211, 0
  v_mov_b32 v212, 0
  v_mov_b32 v213, 0
  v_mov_b32 v214, 0
  v_mov_b32 v215, 0
  v_mov_b32 v216, 0
  v_mov_b32 v217, 0
  v_mov_b32 v218, 0
  v_mov_b32 v219, 0
  v_mov_b32 v220, 0
  v_mov_b32 v221, 0
  v_mov_b32 v222, 0
  v_mov_b32 v223, 0
  v_lshlrev_b32 v18, 4, v0
  s_lshl_b32 s84, s81, 15
  s_lshl_b32 s85, s82, 11
  s_add_u32 s84, s84, s85
  s_add_u32 s84, s84, 98304
  v_add_u32 v18, s84, v18
  v_lshlrev_b32 v19, 4, v0
  s_lshl_b32 s84, s81, 15
  s_lshl_b32 s85, s82, 13
  s_add_u32 s84, s84, s85
  s_add_u32 s84, s84, 98304
  v_add_u32 v19, s84, v19
  v_lshlrev_b32 v20, 10, v4
  v_lshlrev_b32 v21, 5, v56
  v_add_u32 v20, v20, v21
  s_lshl_b32 s84, s39, 7
  s_lshr_b32 s85, s82, 1
  s_lshl_b32 s85, s85, 6
  s_add_u32 s84, s84, s85
  s_and_b32 s85, s82, 1
  s_lshl_b32 s85, s85, 4
  s_add_u32 s84, s84, s85
  v_add_u32 v20, s84, v20
  s_lshl_b32 s83, s36, 6
  v_add_u32 v2, s83, v0
  v_lshlrev_b32_e64 v7, 4, v2
  v_add_u32 v7, 0x400000, v7
  v_lshlrev_b32 v21, 3, v2
  s_lshl_b32 s86, s33, 7
  s_lshl_b32 s84, s32, 3
  s_add_u32 s86, s86, s84
  s_add_u32 s86, s86, s34
  s_lshr_b32 s84, s86, 2
  s_lshl_b32 s84, s84, 7
  s_and_b32 s85, s86, 3
  s_lshl_b32 s85, s85, 2
  s_add_u32 s84, s84, s85
  s_add_u32 s84, s84, 0x430000
  v_lshlrev_b32 v25, 13, v0
  v_add_u32 v25, s84, v25
  s_and_b32 s84, s50, 15
  s_lshl_b32 s84, s84, 13
  s_add_u32 s84, s84, 0x430000
  s_lshr_b32 s85, s38, 1
  s_lshl_b32 s85, s85, 1
  s_add_u32 s85, s85, 32
  v_and_b32 v24, 1, v0
  v_add_u32 v24, s85, v24
  v_cmp_gt_u32 vcc, 32, v0
  s_nop 1
  v_cndmask_b32 v24, v24, v0, vcc
  v_lshlrev_b32 v24, 7, v24
  v_add_u32 v24, s84, v24
  s_waitcnt vmcnt(0)
  s_barrier
  s_cmp_lt_u32 s36, 4
  s_cbranch_scc1 POLL_OK
  s_cmp_lg_u32 s36, 4
  s_cbranch_scc1 NOFLAG
  v_mov_b32 v26, s51
  v_cmp_gt_u32 vcc, 16, v0
  s_nop 0
  s_and_saveexec_b64 s[86:87], vcc
  buffer_store_dword v26, v25, s[24:27], 0 offen sc1
  s_mov_b64 exec, s[86:87]
NOFLAG:
  s_cmp_lg_u32 s36, 4
  s_cbranch_scc1 POLL_OK
  s_mov_b32 s84, 0
  s_mov_b32 exec_hi, 3
  buffer_load_dwordx4 v[28:31], v24, s[24:27], 0 offen sc1
POLL:
  s_waitcnt vmcnt(0)
  v_xor_b32 v28, s51, v28
  v_xor_b32 v29, s51, v29
  v_xor_b32 v30, s51, v30
  v_xor_b32 v31, s51, v31
  v_or_b32 v28, v28, v29
  v_or_b32 v30, v30, v31
  v_or_b32 v28, v28, v30
  v_cmp_ne_u32 vcc, 0, v28
  s_cbranch_vccz POLL_DONE
  buffer_load_dwordx4 v[28:31], v24, s[24:27], 0 offen sc1
  s_add_u32 s84, s84, 1
  s_cmp_lt_u32 s84, 0x40000
  s_cbranch_scc1 POLL
POLL_DONE:
  s_mov_b64 exec, -1
  s_branch POLL_B10
POLL_OK:
  s_waitcnt vmcnt(0) lgkmcnt(0)
POLL_B10:
  s_barrier
  s_cmp_lt_u32 s36, 4
  s_cbranch_scc1 NOYP
  s_setprio 1
NOYP:
  buffer_load_dwordx4 v[96:99], v10, s[24:27], 0 offen offset:0 sc1
  buffer_load_dwordx4 v[100:103], v10, s[24:27], 0 offen offset:1024 sc1
  s_mov_b32 s84, 0
  s_nop 0
  buffer_load_dwordx4 v[224:227], v7, s[24:27], s84 offen sc1
  s_mov_b32 s84, 8192
  buffer_load_dwordx4 v[228:231], v7, s[24:27], s84 offen sc1
  s_mov_b32 s84, 16384
  buffer_load_dwordx4 v[232:235], v7, s[24:27], s84 offen sc1
  s_mov_b32 s84, 24576
  buffer_load_dwordx4 v[236:239], v7, s[24:27], s84 offen sc1
  s_mov_b32 s84, 32768
  v_cmp_gt_u32 vcc, 128, v2
  s_nop 0
  s_and_saveexec_b64 s[86:87], vcc
  buffer_load_dwordx4 v[240:243], v7, s[24:27], s84 offen sc1
  s_mov_b64 exec, s[86:87]
  s_nop 0
  ds_read_b64_tr_b16 v[144:145], v14 offset:0
  ds_read_b64_tr_b16 v[146:147], v14 offset:512
  ds_read_b64_tr_b16 v[148:149], v15 offset:0
  ds_read_b64_tr_b16 v[150:151], v15 offset:512
  ds_read_b64_tr_b16 v[152:153], v14 offset:2048
  ds_read_b64_tr_b16 v[154:155], v14 offset:2560
  ds_read_b64_tr_b16 v[156:157], v15 offset:2048
  ds_read_b64_tr_b16 v[158:159], v15 offset:2560
  s_waitcnt lgkmcnt(4) vmcnt(6)
  s_nop 0
  v_mfma_f32_32x32x16_bf16 v[192:207], v[144:147], v[96:99], v[192:207]
  v_mfma_f32_32x32x16_bf16 v[208:223], v[148:151], v[96:99], v[208:223]
  ds_read_b64_tr_b16 v[144:145], v14 offset:4096
  ds_read_b64_tr_b16 v[146:147], v14 offset:4608
  ds_read_b64_tr_b16 v[148:149], v15 offset:4096
  ds_read_b64_tr_b16 v[150:151], v15 offset:4608
  s_waitcnt lgkmcnt(4) vmcnt(5)
  s_nop 0
  v_mfma_f32_32x32x16_bf16 v[192:207], v[152:155], v[100:103], v[192:207]
  v_mfma_f32_32x32x16_bf16 v[208:223], v[156:159], v[100:103], v[208:223]
  ds_read_b64_tr_b16 v[152:153], v14 offset:6144
  ds_read_b64_tr_b16 v[154:155], v14 offset:6656
  ds_read_b64_tr_b16 v[156:157], v15 offset:6144
  ds_read_b64_tr_b16 v[158:159], v15 offset:6656
  buffer_load_dword v6, v5, s[24:27], 0 offen sc1
  buffer_load_dwordx4 v[64:67], v8, s[24:27], 0 offen offset:0 sc1
  buffer_load_dwordx4 v[104:107], v10, s[24:27], 0 offen offset:2048 sc1
  buffer_load_dwordx4 v[68:71], v8, s[24:27], 0 offen offset:1024 sc1
  s_waitcnt vmcnt(4)
  s_nop 0
  v_cvt_pk_bf16_f32 v224, v224, v225
  v_cvt_pk_bf16_f32 v225, v226, v227
  ds_write_b64 v21, v[224:225] offset:0
  v_cvt_pk_bf16_f32 v228, v228, v229
  v_cvt_pk_bf16_f32 v229, v230, v231
  ds_write_b64 v21, v[228:229] offset:4096
  v_cvt_pk_bf16_f32 v232, v232, v233
  v_cvt_pk_bf16_f32 v233, v234, v235
  ds_write_b64 v21, v[232:233] offset:8192
  v_cvt_pk_bf16_f32 v236, v236, v237
  v_cvt_pk_bf16_f32 v237, v238, v239
  ds_write_b64 v21, v[236:237] offset:12288
  v_cvt_pk_bf16_f32 v240, v240, v241
  v_cvt_pk_bf16_f32 v241, v242, v243
  v_cmp_gt_u32 vcc, 128, v2
  s_nop 0
  s_and_saveexec_b64 s[86:87], vcc
  ds_write_b64 v21, v[240:241] offset:16384
  s_mov_b64 exec, s[86:87]
  s_nop 0
  ds_read_b64_tr_b16 v[128:129], v12 offset:0
  ds_read_b64_tr_b16 v[130:131], v12 offset:1024
  ds_read_b64_tr_b16 v[132:133], v13 offset:0
  ds_read_b64_tr_b16 v[134:135], v13 offset:1024
  buffer_load_dwordx4 v[108:111], v10, s[24:27], 0 offen offset:3072 sc1
  buffer_load_dwordx4 v[72:75], v8, s[24:27], 0 offen offset:2048 sc1
  buffer_load_dwordx4 v[112:115], v11, s[24:27], 0 offen offset:0 sc1
  buffer_load_dwordx4 v[76:79], v8, s[24:27], 0 offen offset:3072 sc1
  s_waitcnt lgkmcnt(0)
  s_barrier
  ds_read_b128 v[56:59], v23 offset:0
  ds_read_b128 v[60:63], v23 offset:544
  ds_read_b64_tr_b16 v[136:137], v12 offset:2048
  ds_read_b64_tr_b16 v[138:139], v12 offset:3072
  ds_read_b64_tr_b16 v[140:141], v13 offset:2048
  ds_read_b64_tr_b16 v[142:143], v13 offset:3072
  s_waitcnt lgkmcnt(5) vmcnt(6)
  v_mfma_f32_32x32x16_bf16 v[24:39], v[56:59], v[64:67], 0
  s_waitcnt lgkmcnt(4) vmcnt(4)
  v_mfma_f32_32x32x16_bf16 v[40:55], v[60:63], v[68:71], 0
  s_waitcnt vmcnt(5)
  s_nop 0
  v_mfma_f32_32x32x16_bf16 v[192:207], v[144:147], v[104:107], v[192:207]
  v_mfma_f32_32x32x16_bf16 v[208:223], v[148:151], v[104:107], v[208:223]
  ds_read_b64_tr_b16 v[144:145], v14 offset:8192
  ds_read_b64_tr_b16 v[146:147], v14 offset:8704
  ds_read_b64_tr_b16 v[148:149], v15 offset:8192
  ds_read_b64_tr_b16 v[150:151], v15 offset:8704
  s_nop 2
  v_add_f32 v32, 0x358637bd, v32
  v_rcp_f32 v32, v32
  s_nop 0
  s_nop 0
  v_pk_mul_f32 v[24:25], v[24:25], v[32:33] op_sel_hi:[1,0]
  v_pk_mul_f32 v[26:27], v[26:27], v[32:33] op_sel_hi:[1,0]
  v_pk_mul_f32 v[28:29], v[28:29], v[32:33] op_sel_hi:[1,0]
  v_pk_mul_f32 v[30:31], v[30:31], v[32:33] op_sel_hi:[1,0]
  v_cvt_pk_bf16_f32 v244, v24, v25
  v_cvt_pk_bf16_f32 v245, v26, v27
  v_cvt_pk_bf16_f32 v246, v28, v29
  v_cvt_pk_bf16_f32 v247, v30, v31
  s_waitcnt lgkmcnt(10) vmcnt(3)
  s_nop 0
  v_mfma_f32_32x32x16_bf16 v[160:175], v[128:131], v[244:247], v[160:175]
  v_add_f32 v48, 0x358637bd, v48
  v_rcp_f32 v48, v48
  s_nop 0
  v_pk_mul_f32 v[40:41], v[40:41], v[48:49] op_sel_hi:[1,0]
  v_pk_mul_f32 v[42:43], v[42:43], v[48:49] op_sel_hi:[1,0]
  v_pk_mul_f32 v[44:45], v[44:45], v[48:49] op_sel_hi:[1,0]
  v_pk_mul_f32 v[46:47], v[46:47], v[48:49] op_sel_hi:[1,0]
  v_mfma_f32_32x32x16_bf16 v[192:207], v[152:155], v[108:111], v[192:207]
  ds_read_b128 v[56:59], v23 offset:1088
  v_cvt_pk_bf16_f32 v248, v40, v41
  v_cvt_pk_bf16_f32 v249, v42, v43
  v_cvt_pk_bf16_f32 v250, v44, v45
  v_cvt_pk_bf16_f32 v251, v46, v47
  v_mfma_f32_32x32x16_bf16 v[176:191], v[132:135], v[244:247], v[176:191]
  buffer_load_dwordx4 v[116:119], v11, s[24:27], 0 offen offset:1024 sc1
  v_mfma_f32_32x32x16_bf16 v[208:223], v[156:159], v[108:111], v[208:223]
  buffer_load_dwordx4 v[80:83], v9, s[24:27], 0 offen offset:0 sc1
  s_waitcnt lgkmcnt(0) vmcnt(4)
  s_nop 0
  v_mfma_f32_32x32x16_bf16 v[24:39], v[56:59], v[72:75], 0
  ds_read_b64_tr_b16 v[128:129], v12 offset:4096
  ds_read_b64_tr_b16 v[130:131], v12 offset:5120
  ds_read_b64_tr_b16 v[132:133], v13 offset:4096
  ds_read_b64_tr_b16 v[134:135], v13 offset:5120
  ds_read_b64_tr_b16 v[152:153], v14 offset:10240
  ds_read_b64_tr_b16 v[154:155], v14 offset:10752
  ds_read_b64_tr_b16 v[156:157], v15 offset:10240
  ds_read_b64_tr_b16 v[158:159], v15 offset:10752
  s_waitcnt lgkmcnt(9) vmcnt(3)
  v_mfma_f32_32x32x16_bf16 v[160:175], v[136:139], v[248:251], v[160:175]
  s_nop 1
  v_add_f32 v32, 0x358637bd, v32
  v_rcp_f32 v32, v32
  s_nop 0
  v_pk_mul_f32 v[24:25], v[24:25], v[32:33] op_sel_hi:[1,0]
  v_pk_mul_f32 v[26:27], v[26:27], v[32:33] op_sel_hi:[1,0]
  v_pk_mul_f32 v[28:29], v[28:29], v[32:33] op_sel_hi:[1,0]
  v_pk_mul_f32 v[30:31], v[30:31], v[32:33] op_sel_hi:[1,0]
  v_mfma_f32_32x32x16_bf16 v[192:207], v[144:147], v[112:115], v[192:207]
  ds_read_b128 v[60:63], v23 offset:1632
  v_cvt_pk_bf16_f32 v244, v24, v25
  v_cvt_pk_bf16_f32 v245, v26, v27
  v_cvt_pk_bf16_f32 v246, v28, v29
  v_cvt_pk_bf16_f32 v247, v30, v31
  v_mfma_f32_32x32x16_bf16 v[176:191], v[140:143], v[248:251], v[176:191]
  buffer_load_dwordx4 v[120:123], v11, s[24:27], 0 offen offset:2048 sc1
  v_mfma_f32_32x32x16_bf16 v[208:223], v[148:151], v[112:115], v[208:223]
  buffer_load_dwordx4 v[84:87], v9, s[24:27], 0 offen offset:1024 sc1
  s_waitcnt lgkmcnt(0) vmcnt(4)
  s_nop 0
  v_mfma_f32_32x32x16_bf16 v[40:55], v[60:63], v[76:79], 0
  ds_read_b64_tr_b16 v[136:137], v12 offset:6144
  ds_read_b64_tr_b16 v[138:139], v12 offset:7168
  ds_read_b64_tr_b16 v[140:141], v13 offset:6144
  ds_read_b64_tr_b16 v[142:143], v13 offset:7168
  ds_read_b64_tr_b16 v[144:145], v14 offset:12288
  ds_read_b64_tr_b16 v[146:147], v14 offset:12800
  ds_read_b64_tr_b16 v[148:149], v15 offset:12288
  ds_read_b64_tr_b16 v[150:151], v15 offset:12800
  s_waitcnt lgkmcnt(9) vmcnt(3)
  v_mfma_f32_32x32x16_bf16 v[160:175], v[128:131], v[244:247], v[160:175]
  s_nop 1
  v_add_f32 v48, 0x358637bd, v48
  v_rcp_f32 v48, v48
  s_nop 0
  v_pk_mul_f32 v[40:41], v[40:41], v[48:49] op_sel_hi:[1,0]
  v_pk_mul_f32 v[42:43], v[42:43], v[48:49] op_sel_hi:[1,0]
  v_pk_mul_f32 v[44:45], v[44:45], v[48:49] op_sel_hi:[1,0]
  v_pk_mul_f32 v[46:47], v[46:47], v[48:49] op_sel_hi:[1,0]
  v_mfma_f32_32x32x16_bf16 v[192:207], v[152:155], v[116:119], v[192:207]
  ds_read_b128 v[56:59], v23 offset:2176
  v_cvt_pk_bf16_f32 v248, v40, v41
  v_cvt_pk_bf16_f32 v249, v42, v43
  v_cvt_pk_bf16_f32 v250, v44, v45
  v_cvt_pk_bf16_f32 v251, v46, v47
  v_mfma_f32_32x32x16_bf16 v[176:191], v[132:135], v[244:247], v[176:191]
  buffer_load_dwordx4 v[124:127], v11, s[24:27], 0 offen offset:3072 sc1
  v_mfma_f32_32x32x16_bf16 v[208:223], v[156:159], v[116:119], v[208:223]
  buffer_load_dwordx4 v[88:91], v9, s[24:27], 0 offen offset:2048 sc1
  s_waitcnt lgkmcnt(0) vmcnt(4)
  s_nop 0
  v_mfma_f32_32x32x16_bf16 v[24:39], v[56:59], v[80:83], 0
  ds_read_b64_tr_b16 v[128:129], v12 offset:8192
  ds_read_b64_tr_b16 v[130:131], v12 offset:9216
  ds_read_b64_tr_b16 v[132:133], v13 offset:8192
  ds_read_b64_tr_b16 v[134:135], v13 offset:9216
  ds_read_b64_tr_b16 v[152:153], v14 offset:14336
  ds_read_b64_tr_b16 v[154:155], v14 offset:14848
  ds_read_b64_tr_b16 v[156:157], v15 offset:14336
  ds_read_b64_tr_b16 v[158:159], v15 offset:14848
  s_waitcnt lgkmcnt(9) vmcnt(3)
  v_mfma_f32_32x32x16_bf16 v[160:175], v[136:139], v[248:251], v[160:175]
  s_nop 1
  v_add_f32 v32, 0x358637bd, v32
  v_rcp_f32 v32, v32
  s_nop 0
  v_pk_mul_f32 v[24:25], v[24:25], v[32:33] op_sel_hi:[1,0]
  v_pk_mul_f32 v[26:27], v[26:27], v[32:33] op_sel_hi:[1,0]
  v_pk_mul_f32 v[28:29], v[28:29], v[32:33] op_sel_hi:[1,0]
  v_pk_mul_f32 v[30:31], v[30:31], v[32:33] op_sel_hi:[1,0]
  v_mfma_f32_32x32x16_bf16 v[192:207], v[144:147], v[120:123], v[192:207]
  ds_read_b128 v[60:63], v23 offset:2720
  v_cvt_pk_bf16_f32 v244, v24, v25
  v_cvt_pk_bf16_f32 v245, v26, v27
  v_cvt_pk_bf16_f32 v246, v28, v29
  v_cvt_pk_bf16_f32 v247, v30, v31
  v_mfma_f32_32x32x16_bf16 v[176:191], v[140:143], v[248:251], v[176:191]
  buffer_load_dwordx4 v[92:95], v9, s[24:27], 0 offen offset:3072 sc1
  v_mfma_f32_32x32x16_bf16 v[208:223], v[148:151], v[120:123], v[208:223]
  s_waitcnt lgkmcnt(0) vmcnt(3)
  s_nop 0
  v_mfma_f32_32x32x16_bf16 v[40:55], v[60:63], v[84:87], 0
  ds_read_b64_tr_b16 v[136:137], v12 offset:10240
  ds_read_b64_tr_b16 v[138:139], v12 offset:11264
  ds_read_b64_tr_b16 v[140:141], v13 offset:10240
  ds_read_b64_tr_b16 v[142:143], v13 offset:11264
  s_waitcnt lgkmcnt(5) vmcnt(2)
  v_mfma_f32_32x32x16_bf16 v[160:175], v[128:131], v[244:247], v[160:175]
  s_nop 5
  v_add_f32 v48, 0x358637bd, v48
  v_rcp_f32 v48, v48
  s_nop 0
  v_pk_mul_f32 v[40:41], v[40:41], v[48:49] op_sel_hi:[1,0]
  v_pk_mul_f32 v[42:43], v[42:43], v[48:49] op_sel_hi:[1,0]
  v_pk_mul_f32 v[44:45], v[44:45], v[48:49] op_sel_hi:[1,0]
  v_pk_mul_f32 v[46:47], v[46:47], v[48:49] op_sel_hi:[1,0]
  v_mfma_f32_32x32x16_bf16 v[192:207], v[152:155], v[124:127], v[192:207]
  ds_read_b128 v[56:59], v23 offset:3264
  v_cvt_pk_bf16_f32 v248, v40, v41
  v_cvt_pk_bf16_f32 v249, v42, v43
  v_cvt_pk_bf16_f32 v250, v44, v45
  v_cvt_pk_bf16_f32 v251, v46, v47
  v_mfma_f32_32x32x16_bf16 v[176:191], v[132:135], v[244:247], v[176:191]
  v_mfma_f32_32x32x16_bf16 v[208:223], v[156:159], v[124:127], v[208:223]
  s_waitcnt lgkmcnt(0) vmcnt(1)
  s_nop 0
  v_mfma_f32_32x32x16_bf16 v[24:39], v[56:59], v[88:91], 0
  ds_read_b64_tr_b16 v[128:129], v12 offset:12288
  ds_read_b64_tr_b16 v[130:131], v12 offset:13312
  ds_read_b64_tr_b16 v[132:133], v13 offset:12288
  ds_read_b64_tr_b16 v[134:135], v13 offset:13312
  s_setprio 0
  s_waitcnt lgkmcnt(5)
  v_mfma_f32_32x32x16_bf16 v[160:175], v[136:139], v[248:251], v[160:175]
  s_nop 4
  v_add_f32 v32, 0x358637bd, v32
  v_rcp_f32 v32, v32
  s_nop 0
  s_nop 0
  v_pk_mul_f32 v[24:25], v[24:25], v[32:33] op_sel_hi:[1,0]
  v_pk_mul_f32 v[26:27], v[26:27], v[32:33] op_sel_hi:[1,0]
  v_pk_mul_f32 v[28:29], v[28:29], v[32:33] op_sel_hi:[1,0]
  v_pk_mul_f32 v[30:31], v[30:31], v[32:33] op_sel_hi:[1,0]
  ds_read_b128 v[60:63], v23 offset:3808
  v_cvt_pk_bf16_f32 v244, v24, v25
  v_cvt_pk_bf16_f32 v245, v26, v27
  v_cvt_pk_bf16_f32 v246, v28, v29
  v_cvt_pk_bf16_f32 v247, v30, v31
  v_mfma_f32_32x32x16_bf16 v[176:191], v[140:143], v[248:251], v[176:191]
  s_waitcnt lgkmcnt(0) vmcnt(0)
  s_nop 0
  v_mfma_f32_32x32x16_bf16 v[40:55], v[60:63], v[92:95], 0
  ds_read_b64_tr_b16 v[136:137], v12 offset:14336
  ds_read_b64_tr_b16 v[138:139], v12 offset:15360
  ds_read_b64_tr_b16 v[140:141], v13 offset:14336
  ds_read_b64_tr_b16 v[142:143], v13 offset:15360
  s_barrier
  v_sub_f32 v226, 1.0, v6
  v_pk_mul_f32 v[192:193], v[192:193], v[226:227] op_sel_hi:[1,0]
  v_pk_mul_f32 v[194:195], v[194:195], v[226:227] op_sel_hi:[1,0]
  v_pk_mul_f32 v[196:197], v[196:197], v[226:227] op_sel_hi:[1,0]
  v_pk_mul_f32 v[198:199], v[198:199], v[226:227] op_sel_hi:[1,0]
  v_pk_mul_f32 v[200:201], v[200:201], v[226:227] op_sel_hi:[1,0]
  v_pk_mul_f32 v[202:203], v[202:203], v[226:227] op_sel_hi:[1,0]
  v_pk_mul_f32 v[204:205], v[204:205], v[226:227] op_sel_hi:[1,0]
  v_pk_mul_f32 v[206:207], v[206:207], v[226:227] op_sel_hi:[1,0]
  v_pk_mul_f32 v[208:209], v[208:209], v[226:227] op_sel_hi:[1,0]
  v_pk_mul_f32 v[210:211], v[210:211], v[226:227] op_sel_hi:[1,0]
  v_pk_mul_f32 v[212:213], v[212:213], v[226:227] op_sel_hi:[1,0]
  v_pk_mul_f32 v[214:215], v[214:215], v[226:227] op_sel_hi:[1,0]
  v_pk_mul_f32 v[216:217], v[216:217], v[226:227] op_sel_hi:[1,0]
  v_pk_mul_f32 v[218:219], v[218:219], v[226:227] op_sel_hi:[1,0]
  v_pk_mul_f32 v[220:221], v[220:221], v[226:227] op_sel_hi:[1,0]
  v_pk_mul_f32 v[222:223], v[222:223], v[226:227] op_sel_hi:[1,0]
  s_waitcnt lgkmcnt(5)
  v_mfma_f32_32x32x16_bf16 v[160:175], v[128:131], v[244:247], v[160:175]
  v_add_f32 v48, 0x358637bd, v48
  v_rcp_f32 v48, v48
  s_nop 0
  s_nop 0
  v_pk_mul_f32 v[40:41], v[40:41], v[48:49] op_sel_hi:[1,0]
  v_pk_mul_f32 v[42:43], v[42:43], v[48:49] op_sel_hi:[1,0]
  v_pk_mul_f32 v[44:45], v[44:45], v[48:49] op_sel_hi:[1,0]
  v_pk_mul_f32 v[46:47], v[46:47], v[48:49] op_sel_hi:[1,0]
  v_cvt_pk_bf16_f32 v248, v40, v41
  v_cvt_pk_bf16_f32 v249, v42, v43
  v_cvt_pk_bf16_f32 v250, v44, v45
  v_cvt_pk_bf16_f32 v251, v46, v47
  v_mfma_f32_32x32x16_bf16 v[176:191], v[132:135], v[244:247], v[176:191]
  s_waitcnt lgkmcnt(0)
  v_mfma_f32_32x32x16_bf16 v[160:175], v[136:139], v[248:251], v[160:175]
  v_mfma_f32_32x32x16_bf16 v[176:191], v[140:143], v[248:251], v[176:191]
  v_mov_b32 v24, v6
  s_nop 7
  s_nop 1
  s_cmp_eq_u32 s82, 1
  s_cbranch_scc1 RED1
  s_cmp_eq_u32 s82, 2
  s_cbranch_scc1 RED2
  s_cmp_eq_u32 s82, 3
  s_cbranch_scc1 RED3
RED0:
  v_pk_fma_f32 v[168:169], v[168:169], v[24:25], v[200:201] op_sel_hi:[1,0,1]
  v_pk_fma_f32 v[170:171], v[170:171], v[24:25], v[202:203] op_sel_hi:[1,0,1]
  v_pk_fma_f32 v[172:173], v[172:173], v[24:25], v[204:205] op_sel_hi:[1,0,1]
  v_pk_fma_f32 v[174:175], v[174:175], v[24:25], v[206:207] op_sel_hi:[1,0,1]
  ds_write_b128 v18, v[168:171] offset:8192
  ds_write_b128 v18, v[172:175] offset:9216
  v_pk_fma_f32 v[176:177], v[176:177], v[24:25], v[208:209] op_sel_hi:[1,0,1]
  v_pk_fma_f32 v[178:179], v[178:179], v[24:25], v[210:211] op_sel_hi:[1,0,1]
  v_pk_fma_f32 v[180:181], v[180:181], v[24:25], v[212:213] op_sel_hi:[1,0,1]
  v_pk_fma_f32 v[182:183], v[182:183], v[24:25], v[214:215] op_sel_hi:[1,0,1]
  ds_write_b128 v18, v[176:179] offset:16384
  ds_write_b128 v18, v[180:183] offset:17408
  v_pk_fma_f32 v[184:185], v[184:185], v[24:25], v[216:217] op_sel_hi:[1,0,1]
  v_pk_fma_f32 v[186:187], v[186:187], v[24:25], v[218:219] op_sel_hi:[1,0,1]
  v_pk_fma_f32 v[188:189], v[188:189], v[24:25], v[220:221] op_sel_hi:[1,0,1]
  v_pk_fma_f32 v[190:191], v[190:191], v[24:25], v[222:223] op_sel_hi:[1,0,1]
  ds_write_b128 v18, v[184:187] offset:24576
  ds_write_b128 v18, v[188:191] offset:25600
  v_pk_fma_f32 v[160:161], v[160:161], v[24:25], v[192:193] op_sel_hi:[1,0,1]
  v_pk_fma_f32 v[162:163], v[162:163], v[24:25], v[194:195] op_sel_hi:[1,0,1]
  v_pk_fma_f32 v[164:165], v[164:165], v[24:25], v[196:197] op_sel_hi:[1,0,1]
  v_pk_fma_f32 v[166:167], v[166:167], v[24:25], v[198:199] op_sel_hi:[1,0,1]
  s_waitcnt lgkmcnt(0)
  s_barrier
  ds_read_b128 v[64:67], v19 offset:2048
  ds_read_b128 v[68:71], v19 offset:3072
  ds_read_b128 v[72:75], v19 offset:4096
  ds_read_b128 v[76:79], v19 offset:5120
  ds_read_b128 v[80:83], v19 offset:6144
  ds_read_b128 v[84:87], v19 offset:7168
  s_waitcnt lgkmcnt(0)
  s_nop 0
  v_pk_add_f32 v[64:65], v[64:65], v[72:73]
  v_pk_add_f32 v[80:81], v[80:81], v[160:161]
  v_pk_add_f32 v[66:67], v[66:67], v[74:75]
  v_pk_add_f32 v[82:83], v[82:83], v[162:163]
  v_pk_add_f32 v[68:69], v[68:69], v[76:77]
  v_pk_add_f32 v[84:85], v[84:85], v[164:165]
  v_pk_add_f32 v[70:71], v[70:71], v[78:79]
  v_pk_add_f32 v[86:87], v[86:87], v[166:167]
  v_pk_add_f32 v[64:65], v[64:65], v[80:81]
  v_pk_add_f32 v[66:67], v[66:67], v[82:83]
  v_pk_add_f32 v[68:69], v[68:69], v[84:85]
  v_pk_add_f32 v[70:71], v[70:71], v[86:87]
  v_cvt_pk_bf16_f32 v128, v64, v65
  v_cvt_pk_bf16_f32 v129, v66, v67
  v_cvt_pk_bf16_f32 v130, v68, v69
  v_cvt_pk_bf16_f32 v131, v70, v71
  buffer_store_dwordx4 v[128:131], v20, s[60:63], 0 offen
  s_branch FIN
RED1:
  s_nop 0
  v_pk_fma_f32 v[160:161], v[160:161], v[24:25], v[192:193] op_sel_hi:[1,0,1]
  v_pk_fma_f32 v[162:163], v[162:163], v[24:25], v[194:195] op_sel_hi:[1,0,1]
  v_pk_fma_f32 v[164:165], v[164:165], v[24:25], v[196:197] op_sel_hi:[1,0,1]
  v_pk_fma_f32 v[166:167], v[166:167], v[24:25], v[198:199] op_sel_hi:[1,0,1]
  ds_write_b128 v18, v[160:163] offset:0
  ds_write_b128 v18, v[164:167] offset:1024
  v_pk_fma_f32 v[176:177], v[176:177], v[24:25], v[208:209] op_sel_hi:[1,0,1]
  v_pk_fma_f32 v[178:179], v[178:179], v[24:25], v[210:211] op_sel_hi:[1,0,1]
  v_pk_fma_f32 v[180:181], v[180:181], v[24:25], v[212:213] op_sel_hi:[1,0,1]
  v_pk_fma_f32 v[182:183], v[182:183], v[24:25], v[214:215] op_sel_hi:[1,0,1]
  ds_write_b128 v18, v[176:179] offset:16384
  ds_write_b128 v18, v[180:183] offset:17408
  v_pk_fma_f32 v[184:185], v[184:185], v[24:25], v[216:217] op_sel_hi:[1,0,1]
  v_pk_fma_f32 v[186:187], v[186:187], v[24:25], v[218:219] op_sel_hi:[1,0,1]
  v_pk_fma_f32 v[188:189], v[188:189], v[24:25], v[220:221] op_sel_hi:[1,0,1]
  v_pk_fma_f32 v[190:191], v[190:191], v[24:25], v[222:223] op_sel_hi:[1,0,1]
  ds_write_b128 v18, v[184:187] offset:24576
  ds_write_b128 v18, v[188:191] offset:25600
  v_pk_fma_f32 v[168:169], v[168:169], v[24:25], v[200:201] op_sel_hi:[1,0,1]
  v_pk_fma_f32 v[170:171], v[170:171], v[24:25], v[202:203] op_sel_hi:[1,0,1]
  v_pk_fma_f32 v[172:173], v[172:173], v[24:25], v[204:205] op_sel_hi:[1,0,1]
  v_pk_fma_f32 v[174:175], v[174:175], v[24:25], v[206:207] op_sel_hi:[1,0,1]
  s_waitcnt lgkmcnt(0)
  s_barrier
  ds_read_b128 v[64:67], v19 offset:0
  ds_read_b128 v[68:71], v19 offset:1024
  ds_read_b128 v[72:75], v19 offset:4096
  ds_read_b128 v[76:79], v19 offset:5120
  ds_read_b128 v[80:83], v19 offset:6144
  ds_read_b128 v[84:87], v19 offset:7168
  s_waitcnt lgkmcnt(0)
  s_nop 0
  v_pk_add_f32 v[64:65], v[64:65], v[72:73]
  v_pk_add_f32 v[80:81], v[80:81], v[168:169]
  v_pk_add_f32 v[66:67], v[66:67], v[74:75]
  v_pk_add_f32 v[82:83], v[82:83], v[170:171]
  v_pk_add_f32 v[68:69], v[68:69], v[76:77]
  v_pk_add_f32 v[84:85], v[84:85], v[172:173]
  v_pk_add_f32 v[70:71], v[70:71], v[78:79]
  v_pk_add_f32 v[86:87], v[86:87], v[174:175]
  v_pk_add_f32 v[64:65], v[64:65], v[80:81]
  v_pk_add_f32 v[66:67], v[66:67], v[82:83]
  v_pk_add_f32 v[68:69], v[68:69], v[84:85]
  v_pk_add_f32 v[70:71], v[70:71], v[86:87]
  v_cvt_pk_bf16_f32 v128, v64, v65
  v_cvt_pk_bf16_f32 v129, v66, v67
  v_cvt_pk_bf16_f32 v130, v68, v69
  v_cvt_pk_bf16_f32 v131, v70, v71
  buffer_store_dwordx4 v[128:131], v20, s[60:63], 0 offen
  s_branch FIN
RED2:
  s_nop 0
  v_pk_fma_f32 v[160:161], v[160:161], v[24:25], v[192:193] op_sel_hi:[1,0,1]
  v_pk_fma_f32 v[162:163], v[162:163], v[24:25], v[194:195] op_sel_hi:[1,0,1]
  v_pk_fma_f32 v[164:165], v[164:165], v[24:25], v[196:197] op_sel_hi:[1,0,1]
  v_pk_fma_f32 v[166:167], v[166:167], v[24:25], v[198:199] op_sel_hi:[1,0,1]
  ds_write_b128 v18, v[160:163] offset:0
  ds_write_b128 v18, v[164:167] offset:1024
  v_pk_fma_f32 v[168:169], v[168:169], v[24:25], v[200:201] op_sel_hi:[1,0,1]
  v_pk_fma_f32 v[170:171], v[170:171], v[24:25], v[202:203] op_sel_hi:[1,0,1]
  v_pk_fma_f32 v[172:173], v[172:173], v[24:25], v[204:205] op_sel_hi:[1,0,1]
  v_pk_fma_f32 v[174:175], v[174:175], v[24:25], v[206:207] op_sel_hi:[1,0,1]
  ds_write_b128 v18, v[168:171] offset:8192
  ds_write_b128 v18, v[172:175] offset:9216
  v_pk_fma_f32 v[184:185], v[184:185], v[24:25], v[216:217] op_sel_hi:[1,0,1]
  v_pk_fma_f32 v[186:187], v[186:187], v[24:25], v[218:219] op_sel_hi:[1,0,1]
  v_pk_fma_f32 v[188:189], v[188:189], v[24:25], v[220:221] op_sel_hi:[1,0,1]
  v_pk_fma_f32 v[190:191], v[190:191], v[24:25], v[222:223] op_sel_hi:[1,0,1]
  ds_write_b128 v18, v[184:187] offset:24576
  ds_write_b128 v18, v[188:191] offset:25600
  v_pk_fma_f32 v[176:177], v[176:177], v[24:25], v[208:209] op_sel_hi:[1,0,1]
  v_pk_fma_f32 v[178:179], v[178:179], v[24:25], v[210:211] op_sel_hi:[1,0,1]
  v_pk_fma_f32 v[180:181], v[180:181], v[24:25], v[212:213] op_sel_hi:[1,0,1]
  v_pk_fma_f32 v[182:183], v[182:183], v[24:25], v[214:215] op_sel_hi:[1,0,1]
  s_waitcnt lgkmcnt(0)
  s_barrier
  ds_read_b128 v[64:67], v19 offset:0
  ds_read_b128 v[68:71], v19 offset:1024
  ds_read_b128 v[72:75], v19 offset:2048
  ds_read_b128 v[76:79], v19 offset:3072
  ds_read_b128 v[80:83], v19 offset:6144
  ds_read_b128 v[84:87], v19 offset:7168
  s_waitcnt lgkmcnt(0)
  s_nop 0
  v_pk_add_f32 v[64:65], v[64:65], v[72:73]
  v_pk_add_f32 v[80:81], v[80:81], v[176:177]
  v_pk_add_f32 v[66:67], v[66:67], v[74:75]
  v_pk_add_f32 v[82:83], v[82:83], v[178:179]
  v_pk_add_f32 v[68:69], v[68:69], v[76:77]
  v_pk_add_f32 v[84:85], v[84:85], v[180:181]
  v_pk_add_f32 v[70:71], v[70:71], v[78:79]
  v_pk_add_f32 v[86:87], v[86:87], v[182:183]
  v_pk_add_f32 v[64:65], v[64:65], v[80:81]
  v_pk_add_f32 v[66:67], v[66:67], v[82:83]
  v_pk_add_f32 v[68:69], v[68:69], v[84:85]
  v_pk_add_f32 v[70:71], v[70:71], v[86:87]
  v_cvt_pk_bf16_f32 v128, v64, v65
  v_cvt_pk_bf16_f32 v129, v66, v67
  v_cvt_pk_bf16_f32 v130, v68, v69
  v_cvt_pk_bf16_f32 v131, v70, v71
  buffer_store_dwordx4 v[128:131], v20, s[60:63], 0 offen
  s_branch FIN
RED3:
  s_nop 0
  v_pk_fma_f32 v[160:161], v[160:161], v[24:25], v[192:193] op_sel_hi:[1,0,1]
  v_pk_fma_f32 v[162:163], v[162:163], v[24:25], v[194:195] op_sel_hi:[1,0,1]
  v_pk_fma_f32 v[164:165], v[164:165], v[24:25], v[196:197] op_sel_hi:[1,0,1]
  v_pk_fma_f32 v[166:167], v[166:167], v[24:25], v[198:199] op_sel_hi:[1,0,1]
  ds_write_b128 v18, v[160:163] offset:0
  ds_write_b128 v18, v[164:167] offset:1024
  v_pk_fma_f32 v[168:169], v[168:169], v[24:25], v[200:201] op_sel_hi:[1,0,1]
  v_pk_fma_f32 v[170:171], v[170:171], v[24:25], v[202:203] op_sel_hi:[1,0,1]
  v_pk_fma_f32 v[172:173], v[172:173], v[24:25], v[204:205] op_sel_hi:[1,0,1]
  v_pk_fma_f32 v[174:175], v[174:175], v[24:25], v[206:207] op_sel_hi:[1,0,1]
  ds_write_b128 v18, v[168:171] offset:8192
  ds_write_b128 v18, v[172:175] offset:9216
  v_pk_fma_f32 v[176:177], v[176:177], v[24:25], v[208:209] op_sel_hi:[1,0,1]
  v_pk_fma_f32 v[178:179], v[178:179], v[24:25], v[210:211] op_sel_hi:[1,0,1]
  v_pk_fma_f32 v[180:181], v[180:181], v[24:25], v[212:213] op_sel_hi:[1,0,1]
  v_pk_fma_f32 v[182:183], v[182:183], v[24:25], v[214:215] op_sel_hi:[1,0,1]
  ds_write_b128 v18, v[176:179] offset:16384
  ds_write_b128 v18, v[180:183] offset:17408
  v_pk_fma_f32 v[184:185], v[184:185], v[24:25], v[216:217] op_sel_hi:[1,0,1]
  v_pk_fma_f32 v[186:187], v[186:187], v[24:25], v[218:219] op_sel_hi:[1,0,1]
  v_pk_fma_f32 v[188:189], v[188:189], v[24:25], v[220:221] op_sel_hi:[1,0,1]
  v_pk_fma_f32 v[190:191], v[190:191], v[24:25], v[222:223] op_sel_hi:[1,0,1]
  s_waitcnt lgkmcnt(0)
  s_barrier
  ds_read_b128 v[64:67], v19 offset:0
  ds_read_b128 v[68:71], v19 offset:1024
  ds_read_b128 v[72:75], v19 offset:2048
  ds_read_b128 v[76:79], v19 offset:3072
  ds_read_b128 v[80:83], v19 offset:4096
  ds_read_b128 v[84:87], v19 offset:5120
  s_waitcnt lgkmcnt(0)
  s_nop 0
  v_pk_add_f32 v[64:65], v[64:65], v[72:73]
  v_pk_add_f32 v[80:81], v[80:81], v[184:185]
  v_pk_add_f32 v[66:67], v[66:67], v[74:75]
  v_pk_add_f32 v[82:83], v[82:83], v[186:187]
  v_pk_add_f32 v[68:69], v[68:69], v[76:77]
  v_pk_add_f32 v[84:85], v[84:85], v[188:189]
  v_pk_add_f32 v[70:71], v[70:71], v[78:79]
  v_pk_add_f32 v[86:87], v[86:87], v[190:191]
  v_pk_add_f32 v[64:65], v[64:65], v[80:81]
  v_pk_add_f32 v[66:67], v[66:67], v[82:83]
  v_pk_add_f32 v[68:69], v[68:69], v[84:85]
  v_pk_add_f32 v[70:71], v[70:71], v[86:87]
  v_cvt_pk_bf16_f32 v128, v64, v65
  v_cvt_pk_bf16_f32 v129, v66, v67
  v_cvt_pk_bf16_f32 v130, v68, v69
  v_cvt_pk_bf16_f32 v131, v70, v71
  buffer_store_dwordx4 v[128:131], v20, s[60:63], 0 offen
  s_branch FIN
FIN:
  s_endpgm
END:
  s_endpgm
CODE_END:
.section .rodata,"a"
.p2align 6
.amdhsa_kernel gated_mix__linear_attn_block__sliding_local_dilated__prompt_kernel
  .amdhsa_next_free_vgpr 256
  .amdhsa_next_free_sgpr 102
  .amdhsa_accum_offset 256
  .amdhsa_group_segment_fixed_size 0
  .amdhsa_kernarg_size 80
  .amdhsa_user_sgpr_count 2
  .amdhsa_user_sgpr_kernarg_segment_ptr 1
  .amdhsa_system_sgpr_workgroup_id_x 1
.end_amdhsa_kernel
```
